```python
import torch

def _softmax(x, axis=-1):
    return torch.softmax(x, dim=axis)
def _gelu(x):
    return torch.nn.functional.gelu(x, approximate="tanh")
def _silu(x):
    return torch.nn.functional.silu(x)
def _sigmoid(x):
    return torch.sigmoid(x)
def _layernorm(x, axis=-1, eps=1e-5):
    m = x.mean(dim=axis, keepdim=True)
    v = x.var(dim=axis, keepdim=True, unbiased=False)
    return (x - m) / torch.sqrt(v + eps)
def _scatter_add(tgt, idx, src, axis=0):
    return tgt.clone().index_add_(axis, idx, src)
def _segment_sum(src, seg, n):
    out = torch.zeros((n,) + src.shape[1:], dtype=src.dtype)
    return out.index_add_(0, seg, src)
def _pad(x, pw):
    flat = tuple(v for pair in reversed(pw) for v in pair)
    return torch.nn.functional.pad(x, flat)

kernel_name = 'sequential_preLN__linear_kernel_hedgehog__glu_gated_geglu__prompt'

def setup_inputs():

    _w = (lambda a: (lambda t: t.to(torch.bfloat16) if t.is_floating_point() else t)(torch.as_tensor(a)))
    def _A_setup():
        B, S, D, H = 1, 2048, 640, 32
        Dh = D // H
        return {
            "x": _w((lambda *s: torch.randn(*s, dtype=torch.bfloat16) * 0.05)(B, S, D)),
            "wqkv": _w((lambda *s: torch.randn(*s, dtype=torch.bfloat16) * 0.2)(D, 3 * D)),
            "w_phi": _w((lambda *s: torch.randn(*s, dtype=torch.bfloat16) * 0.2)(H, Dh, Dh) * (Dh ** -0.5)),
            "wo": _w((lambda *s: torch.randn(*s, dtype=torch.bfloat16) * 0.05)(D, D)),
        }
    _A_in = _A_setup()

    def _B_setup():
        B, S, Dm, Df = 1, 2048, 640, 1728
        return {
            "x": _w((lambda *s: torch.randn(*s, dtype=torch.bfloat16) * 0.05)(B, S, Dm)),
            "w_gate": _w((lambda *s: torch.randn(*s, dtype=torch.bfloat16) * 0.4)(Dm, Df) * (Dm ** -0.5)),
            "w_up": _w((lambda *s: torch.randn(*s, dtype=torch.bfloat16) * 0.4)(Dm, Df) * (Dm ** -0.5)),
            "w_down": _w((lambda *s: torch.randn(*s, dtype=torch.bfloat16) * 0.4)(Df, Dm) * (Df ** -0.5)),
        }
    _B_in = _B_setup()

    return {
        "A_x": _A_in["x"],
        "A_wqkv": _A_in["wqkv"],
        "A_w_phi": _A_in["w_phi"],
        "A_wo": _A_in["wo"],
        "B_x": _B_in["x"],
        "B_w_gate": _B_in["w_gate"],
        "B_w_up": _B_in["w_up"],
        "B_w_down": _B_in["w_down"],
    }

def reference(A_x, A_wqkv, A_w_phi, A_wo, B_x, B_w_gate, B_w_up, B_w_down):
    def _A_ref(x, wqkv, w_phi, wo):
        B, S, D = x.shape
        H = 32; Dh = D // H
        qkv = (lambda x, *d: x.permute(*d))((x @ wqkv).reshape(B, S, 3, H, Dh), 2, 0, 3, 1, 4)
        q, k, v = qkv[0], qkv[1], qkv[2]
        pq = torch.einsum("bhsd,hdf->bhsf", q, w_phi)
        pk = torch.einsum("bhsd,hdf->bhsf", k, w_phi)
        phi_q = torch.concatenate([_softmax(pq, axis=-1), _softmax(-pq, axis=-1)], axis=-1)
        phi_k = torch.concatenate([_softmax(pk, axis=-1), _softmax(-pk, axis=-1)], axis=-1)
        kv = torch.einsum("bhsf,bhsd->bhfd", phi_k, v)
        z  = torch.einsum("bhsf->bhf", phi_k)
        num = torch.einsum("bhqf,bhfd->bhqd", phi_q, kv)
        den = torch.einsum("bhqf,bhf->bhq", phi_q, z)[..., None] + 1e-6
        o = num / den
        return (lambda x, *d: x.permute(*d))(o, 0, 2, 1, 3).reshape(B, S, D) @ wo

    def _B_ref(x, w_gate, w_up, w_down):
        g = torch.einsum("bsd,df->bsf", x, w_gate)
        u = torch.einsum("bsd,df->bsf", x, w_up)
        h = _gelu(g) * u
        return torch.einsum("bsf,fd->bsd", h, w_down)

    x = A_x
    h = x + _A_ref(_layernorm(x, axis=-1), A_wqkv, A_w_phi, A_wo)
    h2 = h + _B_ref(_layernorm(h, axis=-1), B_w_gate, B_w_up, B_w_down)
    return h2
```

```asm
; @launch grid=(256,1,1) block=(256,1,1) lds=163840
.amdgcn_target "amdgcn-amd-amdhsa--gfx950"
.text
.globl sequential_preLN__linear_kernel_hedgehog__glu_gated_geglu__prompt_kernel
.p2align 8
.type sequential_preLN__linear_kernel_hedgehog__glu_gated_geglu__prompt_kernel,@function
sequential_preLN__linear_kernel_hedgehog__glu_gated_geglu__prompt_kernel:
  s_memrealtime s[98:99]
  s_load_dwordx2 s[20:21], s[0:1], 80
  s_load_dwordx2 s[4:5], s[0:1], 0
  s_load_dwordx4 s[12:15], s[0:1], 8
  s_load_dwordx2 s[16:17], s[0:1], 24
  s_load_dwordx2 s[6:7], s[0:1], 64
  s_load_dwordx2 s[18:19], s[0:1], 72
  s_load_dwordx4 s[56:59], s[0:1], 40
  s_load_dwordx2 s[62:63], s[0:1], 56
  v_lshrrev_b32 v1, 6, v0
  v_and_b32 v2, 63, v0
  v_readfirstlane_b32 s95, v1
  s_cmp_ge_u32 s2, 256
  s_cbranch_scc1 M_exit
  v_lshlrev_b32 v3, 4, v2
  v_lshrrev_b32 v4, 5, v2
  v_and_b32 v5, 31, v2
  s_mul_i32 s3, s95, 10240
  s_bfe_u32 s42, s2, 0x20001
  s_lshl_b32 s42, s42, 2
  s_bfe_u32 s40, s2, 0x20003
  s_add_u32 s42, s42, s40
  s_and_b32 s43, s2, 1
  s_lshl_b32 s43, s43, 3
  s_lshr_b32 s40, s2, 5
  s_add_u32 s43, s43, s40
  s_getpc_b64 s[100:101]
P0_pc:
  s_cmp_ge_u32 s2, 8
  s_cbranch_scc1 P0_nopf
  v_lshlrev_b32 v8, 7, v0
  v_mov_b32 v11, s101
  v_cmp_gt_u32 vcc, 6144, v8
  s_nop 1
  s_and_saveexec_b64 s[40:41], vcc
  s_cbranch_execz P0_pf0
  v_add_co_u32 v10, vcc, s100, v8
  s_nop 1
  v_addc_co_u32 v11, vcc, 0, v11, vcc
  global_load_dword v255, v[10:11], off
P0_pf0:
  s_mov_b64 exec, s[40:41]
P0_nopf:
  v_lshrrev_b32 v6, 5, v0
  v_mul_u32_u24 v7, 1280, v6
  v_lshl_add_u32 v7, v5, 3, v7
  s_lshl_b32 s44, s42, 4
  s_add_u32 s44, s44, s43
  s_mul_i32 s40, s44, 10240
  s_mov_b32 s26, 2621440
  s_mov_b32 s27, 0x20000
  s_mov_b32 s30, 2457600
  s_mov_b32 s31, 0x20000
  s_mov_b32 s35, 0x20000
  s_movk_i32 s45, 13108
  s_mul_i32 s46, s42, 153600
  s_mul_i32 s47, s43, 80
  s_add_u32 s46, s46, s47
  s_mul_i32 s47, s43, 1600
  s_lshl_b32 s48, s95, 10
  v_add_u32 v8, 0, v0
  v_min_u32 v8, 599, v8
  v_mul_u32_u24 v11, s45, v8
  v_lshrrev_b32 v11, 16, v11
  v_mul_u32_u24 v11, 1200, v11
  v_lshl_add_u32 v8, v8, 4, v11
  v_add_u32 v9, 256, v0
  v_min_u32 v9, 599, v9
  v_mul_u32_u24 v11, s45, v9
  v_lshrrev_b32 v11, 16, v11
  v_mul_u32_u24 v11, 1200, v11
  v_lshl_add_u32 v9, v9, 4, v11
  v_add_u32 v10, 512, v0
  v_min_u32 v10, 599, v10
  v_mul_u32_u24 v11, s45, v10
  v_lshrrev_b32 v11, 16, v11
  v_mul_u32_u24 v11, 1200, v11
  v_lshl_add_u32 v10, v10, 4, v11
  v_subrev_u32 v11, 128, v0
  v_min_u32 v11, 99, v11
  v_lshlrev_b32 v11, 4, v11
  s_cmp_ge_u32 s95, 2
  s_cselect_b64 vcc, -1, 0
  s_cselect_b32 s34, 25600, s30
  s_cselect_b32 s47, s47, s46
  v_cndmask_b32 v10, v10, v11, vcc
  s_waitcnt lgkmcnt(0)
  s_cselect_b32 s32, s14, s12
  s_cselect_b32 s33, s15, s13
  s_mov_b32 s24, s4
  s_mov_b32 s25, s5
  s_mov_b32 s28, s12
  s_mov_b32 s29, s13
  s_add_u32 m0, s48, 18432
  s_nop 0
  buffer_load_dwordx4 v10, s[32:35], s47 offen  lds
  s_add_u32 m0, s48, 10240
  s_nop 0
  buffer_load_dwordx4 v8, s[28:31], s46 offen nt lds
  buffer_load_dwordx2 v[24:25], v7, s[24:27], s40 offen offset:0 nt
  buffer_load_dwordx2 v[26:27], v7, s[24:27], s40 offen offset:256 nt
  buffer_load_dwordx2 v[28:29], v7, s[24:27], s40 offen offset:512 nt
  buffer_load_dwordx2 v[30:31], v7, s[24:27], s40 offen offset:768 nt
  buffer_load_dwordx2 v[32:33], v7, s[24:27], s40 offen offset:1024 nt
  s_add_u32 m0, s48, 14336
  s_nop 0
  buffer_load_dwordx4 v9, s[28:31], s46 offen nt lds
  s_mov_b32 s64, s18
  s_mov_b32 s65, s19
  s_mov_b32 s66, 256
  s_mov_b32 s67, 0x20000
  s_add_u32 s8, s20, 5373952
  s_addc_u32 s9, s21, 0
  s_mov_b32 s10, 131072
  s_mov_b32 s11, 0x20000
  s_add_u32 s68, s20, 5373952
  s_addc_u32 s69, s21, 0
  s_mov_b32 s70, 241664
  s_mov_b32 s71, 0x20000
  s_lshl_b32 s40, s2, 2
  s_add_u32 s40, s40, s95
  s_lshl_b32 s40, s40, 7
  v_lshlrev_b32 v8, 17, v2
  buffer_load_dword v254, v8, s[68:71], s40 offen sc0 sc1
  v_mov_b32 v16, 0
  s_or_b32 s40, s2, s95
  s_cmp_lg_u32 s40, 0
  s_cbranch_scc1 P0_non
  s_or_b32 s40, s98, 1
  s_mov_b64 exec, 1
  v_mov_b32 v8, s40
  buffer_store_dword v8, v16, s[64:67], 0 offen sc0 sc1
  s_mov_b64 exec, -1
P0_non:
  s_mov_b32 s28, s20
  s_mov_b32 s29, s21
  s_mov_b32 s30, 2621440
  s_mov_b32 s31, 0x20000
  s_add_u32 s32, s20, 2621440
  s_addc_u32 s33, s21, 0
  s_mov_b32 s34, 2457600
  s_mov_b32 s35, 0x20000
  v_lshrrev_b32 v8, 1, v5
  v_xor_b32 v7, v6, v8
  v_and_b32 v7, 7, v7
  v_lshlrev_b32 v7, 4, v7
  v_lshl_add_u32 v7, v8, 7, v7
  v_and_b32 v8, 1, v5
  v_lshl_add_u32 v7, v8, 3, v7
  v_lshrrev_b32 v10, 3, v0
  v_xor_b32 v18, v0, v10
  v_and_b32 v18, 7, v18
  v_lshlrev_b32 v18, 4, v18
  v_lshl_add_u32 v18, v10, 7, v18
  v_and_b32 v19, 7, v0
  v_lshlrev_b32 v19, 4, v19
  v_lshl_add_u32 v19, v10, 9, v19
  s_lshr_b32 s52, s44, 2
  s_mul_i32 s52, s52, 40960
  s_and_b32 s53, s44, 3
  s_lshl_b32 s53, s53, 7
  s_add_u32 s52, s52, s53
  s_add_u32 s53, s52, 16384
  s_add_u32 s54, s52, 32768
  s_mov_b32 s41, 0xffff0000
  s_and_b32 s45, s95, 1
  s_lshr_b32 s46, s95, 1
  v_and_b32 v8, 0x13, v5
  v_lshrrev_b32 v9, 1, v5
  v_and_b32 v9, 4, v9
  v_lshlrev_b32 v10, 1, v5
  v_and_b32 v10, 8, v10
  v_or3_b32 v8, v8, v9, v10
  s_lshl_b32 s47, s46, 5
  v_add_u32 v8, s47, v8
  v_min_u32 v8, 39, v8
  v_mul_u32_u24 v8, 240, v8
  s_mul_i32 s47, s45, 40
  s_add_u32 s47, s47, 10240
  v_add_u32 v21, s47, v8
  v_lshl_add_u32 v20, v4, 4, v21
  v_bfe_u32 v8, v2, 2, 2
  v_lshl_add_u32 v8, v4, 3, v8
  v_mul_u32_u24 v8, 40, v8
  v_bfe_u32 v9, v2, 4, 1
  v_lshl_add_u32 v8, v9, 5, v8
  v_and_b32 v9, 3, v2
  v_lshl_add_u32 v8, v9, 3, v8
  s_mul_i32 s47, s45, 800
  s_add_u32 s47, s47, 20480
  v_add_u32 v22, s47, v8
  v_mov_b32 v70, 0
  v_mov_b32 v71, 0
  v_mov_b32 v78, 0
  v_mov_b32 v79, 0
  v_mov_b32 v86, 0
  v_mov_b32 v87, 0
  v_add_u32 v8, 2, v5
  v_cmp_gt_u32 vcc, 18, v5
  s_nop 1
  v_cndmask_b32 v8, v8, v5, vcc
  v_bfe_u32 v9, v8, 2, 1
  v_mul_u32_u24 v9, 10, v9
  v_lshrrev_b32 v10, 3, v8
  v_lshl_add_u32 v9, v10, 2, v9
  v_and_b32 v10, 3, v8
  v_add_u32 v9, v9, v10
  v_lshlrev_b32 v10, 3, v4
  v_sub_u32 v9, v9, v10
  v_and_b32 v10, 1, v9
  v_lshlrev_b32 v10, 4, v10
  v_mov_b32 v8, 0x3f80
  v_lshlrev_b32 v10, v10, v8
  v_lshrrev_b32 v9, 1, v9
  v_cmp_eq_u32 vcc, 0, v9
  s_nop 1
  v_cndmask_b32 v112, 0, v10, vcc
  v_cmp_eq_u32 vcc, 1, v9
  s_nop 1
  v_cndmask_b32 v113, 0, v10, vcc
  v_cmp_eq_u32 vcc, 2, v9
  s_nop 1
  v_cndmask_b32 v114, 0, v10, vcc
  v_cmp_eq_u32 vcc, 3, v9
  s_nop 1
  v_cndmask_b32 v115, 0, v10, vcc
  v_cmp_eq_u32 vcc, 8, v9
  s_nop 1
  v_cndmask_b32 v116, 0, v10, vcc
  v_cmp_eq_u32 vcc, 9, v9
  s_nop 1
  v_cndmask_b32 v117, 0, v10, vcc
  v_mov_b32 v118, 0
  v_mov_b32 v119, 0
  v_mov_b32 v94, 0
  v_mov_b32 v95, 0
  s_mul_i32 s40, s42, 5
  s_lshl_b32 s47, s46, 2
  s_add_u32 s40, s40, s47
  v_add_u32 v12, s40, v4
  v_lshrrev_b32 v11, 1, v12
  v_mul_u32_u24 v14, 768, v11
  v_mul_u32_u24 v11, 3072, v11
  v_and_b32 v12, 1, v12
  v_lshl_add_u32 v11, v12, 9, v11
  v_mul_u32_u24 v12, 384, v12
  v_add_u32 v14, v14, v12
  v_add_u32 v14, 119808, v14
  v_add_u32 v8, 40, v5
  v_lshrrev_b32 v9, 4, v8
  v_cmp_eq_u32 vcc, 3, v9
  s_nop 1
  v_cndmask_b32 v15, v11, v14, vcc
  v_mov_b32 v123, 3072
  v_mov_b32 v10, 768
  v_cndmask_b32 v123, v123, v10, vcc
  v_lshl_add_u32 v120, v9, 10, v15
  v_bfe_u32 v10, v8, 2, 2
  v_lshl_add_u32 v120, v10, 7, v120
  v_and_b32 v10, 3, v8
  v_lshl_add_u32 v120, v10, 4, v120
  v_add_u32 v8, 0, v5
  v_lshrrev_b32 v9, 4, v8
  v_lshl_add_u32 v121, v9, 10, v11
  v_bfe_u32 v10, v8, 2, 2
  v_lshl_add_u32 v121, v10, 7, v121
  v_and_b32 v10, 3, v8
  v_lshl_add_u32 v121, v10, 4, v121
  v_add_u32 v8, 20, v5
  v_lshrrev_b32 v9, 4, v8
  v_lshl_add_u32 v122, v9, 10, v11
  v_bfe_u32 v10, v8, 2, 2
  v_lshl_add_u32 v122, v10, 7, v122
  v_and_b32 v10, 3, v8
  v_lshl_add_u32 v122, v10, 4, v122
  v_add_u32 v123, v123, v120
  s_mul_i32 s48, s43, 153600
  s_lshl_b32 s49, s45, 6
  s_add_u32 s48, s48, s49
  s_mov_b32 s50, 0x3fb8aa3b
  s_add_u32 s24, s20, 5111808
  s_addc_u32 s25, s21, 0
  s_mov_b32 s26, 122880
  s_mov_b32 s27, 0x20000
  v_mov_b32 v60, 0
  v_mov_b32 v61, 0
  v_mov_b32 v62, 0
  v_mov_b32 v63, 0
  s_mul_i32 s22, s43, 7680
  s_lshl_b32 s23, s42, 9
  s_add_u32 s22, s22, s23
  s_cmp_eq_u32 s42, 15
  s_cselect_b32 s22, 0x10000000, s22
  v_cmp_gt_u32 vcc, 32, v0
  v_mov_b32 v13, 0x10000000
  s_nop 0
  v_cndmask_b32 v13, v13, v3, vcc
  s_waitcnt vmcnt(2)
  buffer_store_dwordx4 v[60:63], v13, s[24:27], s22 offen sc1
  v_lshlrev_b32 v36, 16, v24
  v_and_b32 v37, s41, v24
  v_lshlrev_b32 v38, 16, v25
  v_and_b32 v39, s41, v25
  v_lshlrev_b32 v40, 16, v26
  v_and_b32 v41, s41, v26
  v_lshlrev_b32 v42, 16, v27
  v_and_b32 v43, s41, v27
  v_lshlrev_b32 v44, 16, v28
  v_and_b32 v45, s41, v28
  v_lshlrev_b32 v46, 16, v29
  v_and_b32 v47, s41, v29
  v_lshlrev_b32 v48, 16, v30
  v_and_b32 v49, s41, v30
  v_lshlrev_b32 v50, 16, v31
  v_and_b32 v51, s41, v31
  v_lshlrev_b32 v52, 16, v32
  v_and_b32 v53, s41, v32
  v_lshlrev_b32 v54, 16, v33
  v_and_b32 v55, s41, v33
  v_pk_add_f32 v[56:57], v[36:37], v[38:39]
  v_pk_add_f32 v[58:59], v[40:41], v[42:43]
  v_pk_add_f32 v[56:57], v[56:57], v[44:45]
  v_pk_add_f32 v[58:59], v[58:59], v[46:47]
  v_pk_add_f32 v[56:57], v[56:57], v[48:49]
  v_pk_add_f32 v[58:59], v[58:59], v[50:51]
  v_pk_add_f32 v[56:57], v[56:57], v[52:53]
  v_pk_add_f32 v[58:59], v[58:59], v[54:55]
  v_pk_add_f32 v[56:57], v[56:57], v[58:59]
  v_add_f32 v56, v56, v57
  s_nop 1
  v_add_f32_dpp v56, v56, v56 quad_perm:[1,0,3,2] row_mask:0xf bank_mask:0xf
  s_nop 1
  v_add_f32_dpp v56, v56, v56 quad_perm:[2,3,0,1] row_mask:0xf bank_mask:0xf
  s_nop 1
  v_add_f32_dpp v56, v56, v56 row_half_mirror row_mask:0xf bank_mask:0xf
  s_nop 1
  v_add_f32_dpp v56, v56, v56 row_mirror row_mask:0xf bank_mask:0xf
  v_mov_b32 v57, v56
  s_nop 1
  v_permlane16_swap_b32 v56, v57
  v_add_f32 v56, v56, v57
  v_mul_f32 v56, 0x3acccccd, v56
  v_pk_add_f32 v[36:37], v[36:37], v[56:57] op_sel_hi:[1,0] neg_lo:[0,1] neg_hi:[0,1]
  v_pk_add_f32 v[38:39], v[38:39], v[56:57] op_sel_hi:[1,0] neg_lo:[0,1] neg_hi:[0,1]
  v_pk_add_f32 v[40:41], v[40:41], v[56:57] op_sel_hi:[1,0] neg_lo:[0,1] neg_hi:[0,1]
  v_pk_add_f32 v[42:43], v[42:43], v[56:57] op_sel_hi:[1,0] neg_lo:[0,1] neg_hi:[0,1]
  v_pk_add_f32 v[44:45], v[44:45], v[56:57] op_sel_hi:[1,0] neg_lo:[0,1] neg_hi:[0,1]
  v_pk_add_f32 v[46:47], v[46:47], v[56:57] op_sel_hi:[1,0] neg_lo:[0,1] neg_hi:[0,1]
  v_pk_add_f32 v[48:49], v[48:49], v[56:57] op_sel_hi:[1,0] neg_lo:[0,1] neg_hi:[0,1]
  v_pk_add_f32 v[50:51], v[50:51], v[56:57] op_sel_hi:[1,0] neg_lo:[0,1] neg_hi:[0,1]
  v_pk_add_f32 v[52:53], v[52:53], v[56:57] op_sel_hi:[1,0] neg_lo:[0,1] neg_hi:[0,1]
  v_pk_add_f32 v[54:55], v[54:55], v[56:57] op_sel_hi:[1,0] neg_lo:[0,1] neg_hi:[0,1]
  v_pk_mul_f32 v[58:59], v[36:37], v[36:37]
  v_pk_fma_f32 v[58:59], v[38:39], v[38:39], v[58:59]
  v_pk_fma_f32 v[58:59], v[40:41], v[40:41], v[58:59]
  v_pk_fma_f32 v[58:59], v[42:43], v[42:43], v[58:59]
  v_pk_fma_f32 v[58:59], v[44:45], v[44:45], v[58:59]
  v_pk_fma_f32 v[58:59], v[46:47], v[46:47], v[58:59]
  v_pk_fma_f32 v[58:59], v[48:49], v[48:49], v[58:59]
  v_pk_fma_f32 v[58:59], v[50:51], v[50:51], v[58:59]
  v_pk_fma_f32 v[58:59], v[52:53], v[52:53], v[58:59]
  v_pk_fma_f32 v[58:59], v[54:55], v[54:55], v[58:59]
  v_add_f32 v58, v58, v59
  s_nop 1
  v_add_f32_dpp v58, v58, v58 quad_perm:[1,0,3,2] row_mask:0xf bank_mask:0xf
  s_nop 1
  v_add_f32_dpp v58, v58, v58 quad_perm:[2,3,0,1] row_mask:0xf bank_mask:0xf
  s_nop 1
  v_add_f32_dpp v58, v58, v58 row_half_mirror row_mask:0xf bank_mask:0xf
  s_nop 1
  v_add_f32_dpp v58, v58, v58 row_mirror row_mask:0xf bank_mask:0xf
  v_mov_b32 v59, v58
  s_nop 1
  v_permlane16_swap_b32 v58, v59
  v_add_f32 v58, v58, v59
  v_mov_b32 v59, 0x3727c5ac
  v_fmac_f32 v59, 0x3acccccd, v58
  v_rsq_f32 v58, v59
  s_nop 0
  v_pk_mul_f32 v[36:37], v[36:37], v[58:59] op_sel_hi:[1,0]
  v_pk_mul_f32 v[38:39], v[38:39], v[58:59] op_sel_hi:[1,0]
  v_pk_mul_f32 v[40:41], v[40:41], v[58:59] op_sel_hi:[1,0]
  v_pk_mul_f32 v[42:43], v[42:43], v[58:59] op_sel_hi:[1,0]
  v_pk_mul_f32 v[44:45], v[44:45], v[58:59] op_sel_hi:[1,0]
  v_pk_mul_f32 v[46:47], v[46:47], v[58:59] op_sel_hi:[1,0]
  v_pk_mul_f32 v[48:49], v[48:49], v[58:59] op_sel_hi:[1,0]
  v_pk_mul_f32 v[50:51], v[50:51], v[58:59] op_sel_hi:[1,0]
  v_pk_mul_f32 v[52:53], v[52:53], v[58:59] op_sel_hi:[1,0]
  v_pk_mul_f32 v[54:55], v[54:55], v[58:59] op_sel_hi:[1,0]
  v_cvt_pk_bf16_f32 v24, v36, v37
  v_cvt_pk_bf16_f32 v25, v38, v39
  v_cvt_pk_bf16_f32 v26, v40, v41
  v_cvt_pk_bf16_f32 v27, v42, v43
  v_cvt_pk_bf16_f32 v28, v44, v45
  v_cvt_pk_bf16_f32 v29, v46, v47
  v_cvt_pk_bf16_f32 v30, v48, v49
  v_cvt_pk_bf16_f32 v31, v50, v51
  v_cvt_pk_bf16_f32 v32, v52, v53
  v_cvt_pk_bf16_f32 v33, v54, v55
  ds_write_b64 v7, v[24:25] offset:0
  ds_write_b64 v7, v[26:27] offset:2048
  ds_write_b64 v7, v[28:29] offset:4096
  ds_write_b64 v7, v[30:31] offset:6144
  ds_write_b64 v7, v[32:33] offset:8192
  s_waitcnt vmcnt(1) lgkmcnt(0)
  s_barrier
  s_lshl_b32 s23, s95, 12
  buffer_load_dword v17, v16, s[64:67], s23 offen sc1
  ds_read_b64_tr_b16 v[88:89], v22
  ds_read_b64_tr_b16 v[90:91], v22 offset:160
  ds_read_b64_tr_b16 v[92:93], v22 offset:640
  ds_read2_b64 v[64:67], v20 offset0:0 offset1:1
  ds_read_b64 v[68:69], v21 offset:32
  ds_read2_b64 v[72:75], v20 offset0:10 offset1:11
  ds_read_b64 v[76:77], v21 offset:112
  ds_read2_b64 v[80:83], v20 offset0:20 offset1:21
  ds_read_b64 v[84:85], v21 offset:192
  ds_read_b128 v[36:39], v18 offset:0
  ds_read_b128 v[40:43], v18 offset:4096
  ds_read_b128 v[44:47], v18 offset:8192
  s_cmp_ge_u32 s95, 2
  s_cselect_b32 s54, 0x10000000, s54
  s_cselect_b32 s49, 0x10000000, s48
  s_cselect_b32 s40, 0, 0xfffff
  s_waitcnt lgkmcnt(9)
  s_mov_b32 exec_lo, 0
  v_mov_b32 v92, 0
  v_mov_b32 v93, 0
  s_mov_b32 exec_lo, -1
  s_waitcnt lgkmcnt(7)
  v_mfma_f32_32x32x16_bf16 v[128:143], v[64:67], v[88:91], 0
  v_mfma_f32_32x32x16_bf16 v[128:143], v[68:71], v[92:95], v[128:143]
  s_waitcnt lgkmcnt(5)
  v_mfma_f32_32x32x16_bf16 v[144:159], v[72:75], v[88:91], 0
  v_mfma_f32_32x32x16_bf16 v[144:159], v[76:79], v[92:95], v[144:159]
  s_waitcnt lgkmcnt(3)
  v_mfma_f32_32x32x16_bf16 v[160:175], v[80:83], v[112:115], 0
  v_mfma_f32_32x32x16_bf16 v[160:175], v[84:87], v[116:119], v[160:175]
  s_waitcnt lgkmcnt(2)
  buffer_store_dwordx4 v[36:39], v19, s[28:31], s52 offen sc1
  s_waitcnt lgkmcnt(1)
  buffer_store_dwordx4 v[40:43], v19, s[28:31], s53 offen sc1
  s_waitcnt lgkmcnt(0)
  buffer_store_dwordx4 v[44:47], v19, s[28:31], s54 offen sc1
  s_mov_b32 exec_lo, 0xfffff
  s_mov_b32 exec_hi, s40
  v_pk_mul_f32 v[128:129], v[128:129], s[50:51] op_sel_hi:[1,0]
  v_pk_mul_f32 v[130:131], v[130:131], s[50:51] op_sel_hi:[1,0]
  v_pk_mul_f32 v[132:133], v[132:133], s[50:51] op_sel_hi:[1,0]
  v_pk_mul_f32 v[134:135], v[134:135], s[50:51] op_sel_hi:[1,0]
  v_pk_mul_f32 v[136:137], v[136:137], s[50:51] op_sel_hi:[1,0]
  v_pk_mul_f32 v[138:139], v[138:139], s[50:51] op_sel_hi:[1,0]
  v_pk_mul_f32 v[140:141], v[140:141], s[50:51] op_sel_hi:[1,0]
  v_pk_mul_f32 v[142:143], v[142:143], s[50:51] op_sel_hi:[1,0]
  v_cvt_pk_bf16_f32 v64, v128, v129
  v_cvt_pk_bf16_f32 v65, v130, v131
  v_cvt_pk_bf16_f32 v66, v132, v133
  v_cvt_pk_bf16_f32 v67, v134, v135
  v_cvt_pk_bf16_f32 v68, v136, v137
  v_cvt_pk_bf16_f32 v69, v138, v139
  v_cvt_pk_bf16_f32 v70, v140, v141
  v_cvt_pk_bf16_f32 v71, v142, v143
  buffer_store_dwordx4 v[64:67], v120, s[32:35], s48 offen sc1
  buffer_store_dwordx4 v[68:71], v123, s[32:35], s49 offen sc1
  v_pk_mul_f32 v[144:145], v[144:145], s[50:51] op_sel_hi:[1,0]
  v_pk_mul_f32 v[146:147], v[146:147], s[50:51] op_sel_hi:[1,0]
  v_pk_mul_f32 v[148:149], v[148:149], s[50:51] op_sel_hi:[1,0]
  v_pk_mul_f32 v[150:151], v[150:151], s[50:51] op_sel_hi:[1,0]
  v_pk_mul_f32 v[152:153], v[152:153], s[50:51] op_sel_hi:[1,0]
  v_pk_mul_f32 v[154:155], v[154:155], s[50:51] op_sel_hi:[1,0]
  v_pk_mul_f32 v[156:157], v[156:157], s[50:51] op_sel_hi:[1,0]
  v_pk_mul_f32 v[158:159], v[158:159], s[50:51] op_sel_hi:[1,0]
  v_cvt_pk_bf16_f32 v72, v144, v145
  v_cvt_pk_bf16_f32 v73, v146, v147
  v_cvt_pk_bf16_f32 v74, v148, v149
  v_cvt_pk_bf16_f32 v75, v150, v151
  v_cvt_pk_bf16_f32 v76, v152, v153
  v_cvt_pk_bf16_f32 v77, v154, v155
  v_cvt_pk_bf16_f32 v78, v156, v157
  v_cvt_pk_bf16_f32 v79, v158, v159
  buffer_store_dwordx4 v[72:75], v121, s[32:35], s48 offen sc1
  buffer_store_dwordx4 v[76:79], v121, s[32:35], s49 offen offset:3072 sc1
  v_cvt_pk_bf16_f32 v80, v160, v161
  v_cvt_pk_bf16_f32 v81, v162, v163
  v_cvt_pk_bf16_f32 v82, v164, v165
  v_cvt_pk_bf16_f32 v83, v166, v167
  v_cvt_pk_bf16_f32 v84, v168, v169
  v_cvt_pk_bf16_f32 v85, v170, v171
  v_cvt_pk_bf16_f32 v86, v172, v173
  v_cvt_pk_bf16_f32 v87, v174, v175
  buffer_store_dwordx4 v[80:83], v122, s[32:35], s48 offen sc1
  buffer_store_dwordx4 v[84:87], v122, s[32:35], s49 offen offset:3072 sc1
  s_mov_b64 exec, -1
  s_lshl_b32 s40, s44, 4
  s_add_u32 s40, s40, 49152
  s_lshl_b32 s41, s43, 8
  s_add_u32 s41, s41, 53248
  s_lshl_b32 s50, s42, 4
  s_add_u32 s50, s50, s41
  v_mov_b32 v10, s50
  v_writelane_b32 v10, s40, 0
  v_lshlrev_b32 v10, 0, v10
  v_add_u32 v10, 0, v10
  s_lshl_b32 s40, s42, 8
  s_lshl_b32 s50, s95, 6
  s_add_u32 s40, s40, s50
  s_add_u32 s40, s40, 49152
  v_and_b32 v12, 3, v2
  v_lshl_add_u32 v12, v12, 4, s40
  v_add_u32 v13, s41, v3
  v_cmp_gt_u32 vcc, 16, v2
  s_nop 1
  v_cndmask_b32 v12, v12, v13, vcc
  s_waitcnt vmcnt(0)
  s_cmp_lg_u32 s95, 0
  s_cbranch_scc1 P0_oth
  s_mov_b32 s92, 0
P0_nspin:
  v_readfirstlane_b32 s93, v17
  s_add_u32 s92, s92, 1
  s_nop 2
  s_cmp_lg_u32 s93, 0
  s_cbranch_scc1 P0_ngo
  s_cmp_gt_u32 s92, 400000
  s_cbranch_scc1 P0_ngo
  buffer_load_dword v17, v16, s[64:67], 0 offen sc1
  s_waitcnt vmcnt(0)
  s_branch P0_nspin
P0_ngo:
  v_mov_b32 v16, 163836
  ds_write_b32 v16, v17
  s_waitcnt lgkmcnt(0)
  s_barrier
  s_mov_b64 exec, 3
  buffer_store_dword v17, v10, s[8:11], 0 offen sc0 sc1
  s_mov_b64 exec, -1
  s_branch P0_sig
P0_oth:
  v_mov_b32 v16, 163836
  s_barrier
  ds_read_b32 v17, v16
  s_waitcnt lgkmcnt(0)
  v_readfirstlane_b32 s93, v17
P0_sig:
  s_sub_u32 s40, s2, 248
  s_cmp_ge_u32 s40, 8
  s_cbranch_scc1 P0_nopf2
  v_lshlrev_b32 v8, 7, v0
  v_add_u32 v8, 6144, v8
  v_mov_b32 v11, s101
  v_cmp_gt_u32 vcc, CODE_END-P0_pc, v8
  s_nop 1
  s_and_saveexec_b64 s[46:47], vcc
  s_cbranch_execz P0_pf1
  v_add_co_u32 v10, vcc, s100, v8
  s_nop 1
  v_addc_co_u32 v11, vcc, 0, v11, vcc
  global_load_dword v255, v[10:11], off
P0_pf1:
  s_mov_b64 exec, s[46:47]
P0_nopf2:
  s_cmp_ge_u32 s2, 108
  s_cselect_b32 s36, s58, s56
  s_cselect_b32 s37, s59, s57
  s_cselect_b32 s56, 1, 0
  s_mov_b32 s38, 2211840
  s_mov_b32 s39, 0x20000
  s_mul_i32 s57, s56, 108
  s_sub_u32 s57, s2, s57
  s_and_b32 s58, s57, 3
  s_lshr_b32 s57, s57, 2
  v_lshrrev_b32 v8, 3, v2
  v_and_b32 v9, 7, v2
  v_lshlrev_b32 v9, 4, v9
  v_mul_u32_u24 v232, 3456, v8
  v_add_u32 v232, v232, v9
  s_mul_i32 s60, s58, 160
  s_mul_i32 s40, s95, 40
  s_add_u32 s60, s60, s40
  s_mul_i32 s60, s60, 3456
  s_lshl_b32 s40, s57, 7
  s_add_u32 s60, s60, s40
  s_cmp_ge_u32 s2, 216
  s_cselect_b32 s60, 0x10000000, s60
  s_mul_i32 s55, s95, 5120
  s_lshl_b32 s51, s95, 12
  s_add_u32 m0, s55, 114688
  s_nop 0
  buffer_load_dwordx4 v232, s[36:39], s60 offen nt lds
  s_add_u32 s60, s60, 27648
  s_add_u32 m0, s55, 115712
  s_nop 0
  buffer_load_dwordx4 v232, s[36:39], s60 offen nt lds
  s_add_u32 s60, s60, 27648
  s_add_u32 m0, s55, 116736
  s_nop 0
  buffer_load_dwordx4 v232, s[36:39], s60 offen nt lds
  s_add_u32 s60, s60, 27648
  s_add_u32 m0, s55, 117760
  s_nop 0
  buffer_load_dwordx4 v232, s[36:39], s60 offen nt lds
  s_add_u32 s60, s60, 27648
  s_add_u32 m0, s55, 118784
  s_nop 0
  buffer_load_dwordx4 v232, s[36:39], s60 offen nt lds
  s_add_u32 s60, s60, 27648
  s_mov_b32 s71, 0x20000
  s_cmp_eq_u32 s95, 3
  s_cbranch_scc1 P0_wo
  s_mov_b32 s68, s62
  s_mov_b32 s69, s63
  s_mov_b32 s70, 2211840
  v_mul_u32_u24 v10, 1280, v8
  v_add_u32 v10, v10, v9
  s_lshl_b32 s40, s2, 1
  s_add_u32 s40, s40, s95
  s_add_u32 s49, s2, 304
  s_cmp_lt_u32 s2, 208
  s_cselect_b32 s49, 999, s49
  s_cmp_eq_u32 s95, 2
  s_cselect_b32 s40, s49, s40
  s_mul_i32 s59, s40, 1171
  s_lshr_b32 s59, s59, 16
  s_mul_i32 s62, s59, 56
  s_sub_u32 s62, s40, s62
  s_mul_i32 s41, s62, 147
  s_lshr_b32 s41, s41, 11
  s_mul_i32 s49, s41, 14
  s_sub_u32 s49, s62, s49
  s_lshl_b32 s41, s41, 1
  s_and_b32 s61, s49, 1
  s_add_u32 s41, s41, s61
  s_mul_i32 s41, s41, 27
  s_andn2_b32 s49, s49, 1
  s_add_u32 s41, s41, s49
  s_mul_i32 s41, s41, 10240
  v_add_u32 v216, s41, v10
  v_add_u32 v218, 133120, v216
  v_add_u32 v219, 143360, v216
  s_movk_i32 s41, 10240
  s_cmp_eq_u32 s49, 12
  s_cselect_b32 s41, 0x10000000, s41
  v_add_u32 v217, s41, v216
  s_lshl_b32 s61, s59, 7
  s_mul_i32 s59, s59, 224
  s_add_u32 s59, s59, s62
  s_lshl_b32 s59, s59, 10
  s_add_u32 s59, s59, 851968
  s_mov_b32 s96, 57344
  s_cmp_ge_u32 s40, 560
  s_branch P0_wt
P0_wo:
  s_mov_b32 s68, s16
  s_mov_b32 s69, s17
  s_mov_b32 s70, 819200
  s_mul_i32 s59, s2, 205
  s_lshr_b32 s59, s59, 12
  s_mul_i32 s62, s59, 20
  s_sub_u32 s62, s2, s62
  v_cmp_le_u32 vcc, 2, v8
  s_nop 1
  v_cndmask_b32 v11, 8, 18, vcc
  v_add_u32 v11, v11, v8
  v_lshrrev_b32 v10, 2, v8
  v_mul_u32_u24 v10, 6, v10
  v_add3_u32 v10, v10, v8, 26
  s_lshl_b32 s40, s62, 2
  s_add_u32 s40, s40, 0
  s_mul_i32 s41, s40, 205
  s_lshr_b32 s41, s41, 10
  s_mul_i32 s49, s41, 5
  s_sub_u32 s40, s40, s49
  s_mul_i32 s41, s41, 40
  s_and_b32 s49, s40, 1
  s_mul_i32 s49, s49, 10
  s_add_u32 s41, s41, s49
  s_cmp_ge_u32 s40, 2
  s_cselect_b64 vcc, -1, 0
  v_cndmask_b32 v216, v8, v11, vcc
  s_cmp_eq_u32 s40, 4
  s_cselect_b64 vcc, -1, 0
  v_cndmask_b32 v216, v216, v10, vcc
  v_add_u32 v216, s41, v216
  v_mul_u32_u24 v216, 1280, v216
  v_add_u32 v216, v216, v9
  s_lshl_b32 s40, s62, 2
  s_add_u32 s40, s40, 1
  s_mul_i32 s41, s40, 205
  s_lshr_b32 s41, s41, 10
  s_mul_i32 s49, s41, 5
  s_sub_u32 s40, s40, s49
  s_mul_i32 s41, s41, 40
  s_and_b32 s49, s40, 1
  s_mul_i32 s49, s49, 10
  s_add_u32 s41, s41, s49
  s_cmp_ge_u32 s40, 2
  s_cselect_b64 vcc, -1, 0
  v_cndmask_b32 v217, v8, v11, vcc
  s_cmp_eq_u32 s40, 4
  s_cselect_b64 vcc, -1, 0
  v_cndmask_b32 v217, v217, v10, vcc
  v_add_u32 v217, s41, v217
  v_mul_u32_u24 v217, 1280, v217
  v_add_u32 v217, v217, v9
  s_lshl_b32 s40, s62, 2
  s_add_u32 s40, s40, 2
  s_mul_i32 s41, s40, 205
  s_lshr_b32 s41, s41, 10
  s_mul_i32 s49, s41, 5
  s_sub_u32 s40, s40, s49
  s_mul_i32 s41, s41, 40
  s_and_b32 s49, s40, 1
  s_mul_i32 s49, s49, 10
  s_add_u32 s41, s41, s49
  s_cmp_ge_u32 s40, 2
  s_cselect_b64 vcc, -1, 0
  v_cndmask_b32 v218, v8, v11, vcc
  s_cmp_eq_u32 s40, 4
  s_cselect_b64 vcc, -1, 0
  v_cndmask_b32 v218, v218, v10, vcc
  v_add_u32 v218, s41, v218
  v_mul_u32_u24 v218, 1280, v218
  v_add_u32 v218, v218, v9
  s_lshl_b32 s40, s62, 2
  s_add_u32 s40, s40, 3
  s_mul_i32 s41, s40, 205
  s_lshr_b32 s41, s41, 10
  s_mul_i32 s49, s41, 5
  s_sub_u32 s40, s40, s49
  s_mul_i32 s41, s41, 40
  s_and_b32 s49, s40, 1
  s_mul_i32 s49, s49, 10
  s_add_u32 s41, s41, s49
  s_cmp_ge_u32 s40, 2
  s_cselect_b64 vcc, -1, 0
  v_cndmask_b32 v219, v8, v11, vcc
  s_cmp_eq_u32 s40, 4
  s_cselect_b64 vcc, -1, 0
  v_cndmask_b32 v219, v219, v10, vcc
  v_add_u32 v219, s41, v219
  v_mul_u32_u24 v219, 1280, v219
  v_add_u32 v219, v219, v9
  s_lshl_b32 s61, s59, 7
  s_mul_i32 s59, s59, 80
  s_add_u32 s59, s59, s62
  s_lshl_b32 s59, s59, 10
  s_mov_b32 s96, 20480
  s_cmp_ge_u32 s2, 200
P0_wt:
  s_cselect_b32 s61, 0x10000000, s61
  s_cselect_b32 s59, 0x10000000, s59
  s_add_u32 m0, s51, 135168
  s_nop 0
  buffer_load_dwordx4 v216, s[68:71], s61 offen nt lds
  s_add_u32 m0, s51, 136192
  s_nop 0
  buffer_load_dwordx4 v217, s[68:71], s61 offen nt lds
  s_add_u32 m0, s51, 137216
  s_nop 0
  buffer_load_dwordx4 v218, s[68:71], s61 offen nt lds
  s_add_u32 m0, s51, 138240
  s_nop 0
  buffer_load_dwordx4 v219, s[68:71], s61 offen nt lds
  s_add_u32 s12, s20, 8847360
  s_addc_u32 s13, s21, 0
  s_mov_b32 s14, 4423680
  s_mov_b32 s15, 0x20000
  s_add_u32 s32, s20, 5505024
  s_addc_u32 s33, s21, 0
  s_mov_b32 s34, 110592
  s_mov_b32 s35, 0x20000
  s_add_u32 s16, s20, 5701632
  s_addc_u32 s17, s21, 0
  s_mov_b32 s18, 3145728
  s_mov_b32 s19, 0x20000
  v_lshrrev_b32 v6, 4, v2
  v_bfe_u32 v7, v2, 2, 2
  v_lshl_add_u32 v7, v6, 3, v7
  v_lshlrev_b32 v7, 7, v7
  v_and_b32 v8, 3, v2
  v_lshl_add_u32 v7, v8, 3, v7
  s_lshl_b32 s45, s95, 5
  s_add_u32 s45, s45, 114688
  v_add_u32 v248, s45, v7
  s_add_u32 s45, s51, 135168
  v_add_u32 v249, s45, v7
  v_bfe_u32 v9, v2, 3, 1
  v_and_b32 v10, 7, v2
  v_mul_u32_u24 v238, 20480, v9
  v_lshlrev_b32 v239, 9, v9
  v_lshl_add_u32 v239, v10, 4, v239
  v_lshl_add_u32 v239, v6, 26, v239
  v_lshl_add_u32 v238, v10, 4, v238
  v_lshl_add_u32 v238, v4, 9, v238
  v_xor_b32 v9, s56, v6
  v_and_b32 v9, 1, v9
  v_lshl_add_u32 v238, v9, 7, v238
  s_lshl_b32 s45, s57, 3
  s_lshl_b32 s46, s95, 1
  s_add_u32 s45, s45, s46
  s_mul_i32 s52, s45, 20480
  s_mul_i32 s47, s58, 5120
  s_add_u32 s52, s52, s47
  s_lshl_b32 s47, s56, 8
  s_add_u32 s52, s52, s47
  s_lshl_b32 s45, s45, 9
  s_add_u32 s45, s45, s47
  s_lshr_b32 s47, s58, 1
  s_xor_b32 s47, s47, s56
  s_lshl_b32 s47, s47, 7
  s_add_u32 s45, s45, s47
  s_and_b32 s47, s58, 1
  s_lshl_b32 s47, s47, 3
  s_add_u32 s58, s45, s47
  s_cmp_ge_u32 s2, 216
  s_cselect_b32 s52, 0x10000000, s52
  s_cselect_b32 s58, 0x10000000, s58
  s_add_u32 s53, s52, 4096
  v_mov_b32 v240, 0x3f803f80
  v_mov_b32 v241, 0x3f803f80
  v_mov_b32 v242, 0x3f803f80
  v_mov_b32 v243, 0x3f803f80
  s_cmp_eq_u32 s95, 3
  s_cselect_b32 s97, s59, 0x10000000
  s_cselect_b32 s59, 0x10000000, s59
  s_add_u32 s64, s20, 5701632
  s_addc_u32 s65, s21, 0
  s_mov_b32 s66, 819200
  s_mov_b32 s67, 0x20000
  s_add_u32 s36, s20, 5111808
  s_addc_u32 s37, s21, 0
  s_mov_b32 s38, 122880
  s_mov_b32 s39, 0x20000
  s_mov_b32 s68, s4
  s_mov_b32 s69, s5
  s_mov_b32 s70, 2621440
  s_mov_b32 s71, 0x20000
  s_bfe_u32 s100, s2, 0x20001
  s_lshl_b32 s100, s100, 3
  s_bfe_u32 s40, s2, 0x30003
  s_add_u32 s100, s100, s40
  s_and_b32 s101, s2, 1
  s_lshl_b32 s101, s101, 2
  s_lshr_b32 s40, s2, 6
  s_add_u32 s101, s101, s40
  s_lshl_b32 s44, s42, 2
  s_add_u32 s44, s44, s95
  s_mul_i32 s45, s44, 40960
  s_mul_i32 s46, s43, 153600
  s_mul_i32 s47, s95, 3072
  s_lshl_b32 s48, s95, 13
  s_mul_i32 s40, s101, 5
  s_lshr_b32 s40, s40, 2
  s_mul_i32 s40, s40, 20
  s_mul_i32 s41, s95, 5
  s_add_u32 s40, s40, s41
  s_lshl_b32 s40, s40, 4
  s_add_u32 s40, s40, 81920
  v_and_b32 v62, 7, v2
  v_min_u32 v62, 4, v62
  v_lshl_add_u32 v62, v62, 4, s40
  v_bfe_u32 v63, v2, 3, 1
  v_mul_u32_u24 v63, 320, v63
  v_add_u32 v62, v62, v63
  s_mul_i32 s22, s101, 100
  s_add_u32 s22, s22, s41
  s_lshl_b32 s22, s22, 10
  v_lshlrev_b32 v6, 7, v4
  v_sub_u32 v6, v3, v6
  v_add_u32 v6, 122880, v6
  v_add_u32 v7, 61440, v3
  s_lshl_b32 s40, s95, 5
  v_add_u32 v11, s40, v5
  v_mul_u32_u24 v11, 272, v11
  v_lshl_add_u32 v11, v4, 7, v11
  v_bfe_u32 v56, v2, 2, 2
  v_lshlrev_b32 v56, 2, v56
  v_lshl_add_u32 v56, v4, 1, v56
  v_mul_u32_u24 v56, 272, v56
  v_bfe_u32 v57, v2, 4, 1
  v_lshl_add_u32 v56, v57, 5, v56
  v_and_b32 v57, 3, v2
  v_lshl_add_u32 v56, v57, 3, v56
  s_lshr_b32 s51, s95, 1
  s_and_b32 s55, s95, 1
  s_lshl_b32 s40, s51, 7
  v_add_u32 v56, s40, v56
  s_mul_i32 s40, s55, 40
  v_add_u32 v57, s40, v56
  s_lshl_b32 s40, s95, 12
  s_add_u32 s40, s40, 40960
  v_mul_u32_u24 v58, 384, v4
  v_lshl_add_u32 v58, v5, 4, v58
  v_add_u32 v58, s40, v58
  v_lshl_add_u32 v59, v2, 2, s40
  v_lshlrev_b32 v60, 2, v2
  s_lshl_b32 s54, s43, 1
  s_add_u32 s54, s54, s51
  s_mul_i32 s54, s54, 3840
  s_mul_i32 s55, s55, 1920
  s_add_u32 s54, s54, s55
  s_lshl_b32 s49, s43, 4
  s_add_u32 s49, s49, s42
  s_lshl_b32 s49, s49, 4
  s_add_u32 s49, s49, 61440
  s_lshl_b32 s49, s49, 0
  s_add_u32 s49, s49, 0
  s_lshl_b32 s50, s2, 4
  s_add_u32 s50, s50, 81920
  s_cmp_eq_u32 s95, 3
  s_cselect_b32 s50, s50, 0x1000000
  s_cmp_eq_u32 s95, 0
  s_cselect_b32 s49, s49, s50
  v_mov_b32 v61, 0x1000000
  v_writelane_b32 v61, s49, 0
  v_mov_b32 v19, s93
  s_lshl_b32 s40, s2, 4
  s_add_u32 s40, s40, 57344
  s_cmp_eq_u32 s95, 2
  s_cselect_b32 s40, s40, s50
  v_mov_b32 v10, 0x1000000
  v_writelane_b32 v10, s40, 0
  s_mov_b32 s57, s50
  s_lshl_b32 s56, s100, 2
  s_add_u32 s56, s56, s95
  s_mul_i32 s56, s56, 20480
  s_mul_i32 s41, s101, 160
  s_add_u32 s56, s56, s41
  s_movk_i32 s41, 6554
  v_add_u32 v8, 0, v2
  v_min_u32 v8, 159, v8
  v_mul_u32_u24 v9, s41, v8
  v_lshrrev_b32 v9, 16, v9
  v_mul_u32_u24 v9, 1120, v9
  v_lshl_add_u32 v16, v8, 4, v9
  v_add_u32 v8, 64, v2
  v_min_u32 v8, 159, v8
  v_mul_u32_u24 v9, s41, v8
  v_lshrrev_b32 v9, 16, v9
  v_mul_u32_u24 v9, 1120, v9
  v_lshl_add_u32 v17, v8, 4, v9
  v_add_u32 v8, 128, v2
  v_min_u32 v8, 159, v8
  v_mul_u32_u24 v9, s41, v8
  v_lshrrev_b32 v9, 16, v9
  v_mul_u32_u24 v9, 1120, v9
  v_lshl_add_u32 v18, v8, 4, v9
  s_mov_b32 s24, s20
  s_mov_b32 s25, s21
  s_mov_b32 s26, 2621440
  s_mov_b32 s27, 0x20000
  s_add_u32 s28, s20, 2621440
  s_addc_u32 s29, s21, 0
  s_add_u32 s28, s28, s46
  s_addc_u32 s29, s29, 0
  s_mov_b32 s30, 153600
  s_mov_b32 s31, 0x20000
  s_mov_b32 s92, 0
M_poll1:
  buffer_load_dword v9, v12, s[8:11], 0 offen sc1
  s_add_u32 s92, s92, 1
  s_cmp_gt_u32 s92, 400000
  s_cbranch_scc1 M_poll1_go
  s_waitcnt vmcnt(0)
  v_cmp_ne_u32 vcc, s93, v9
  s_nop 4
  s_cbranch_vccnz M_poll1
M_poll1_go:
  s_waitcnt vmcnt(0)
  s_add_u32 m0, s47, 0
  buffer_load_dwordx4 a[0:3], v3, s[24:27], s45 offen sc1
  buffer_load_dwordx4 v3, s[28:31], m0 offen offset:0 sc1 lds
  buffer_load_dwordx4 v3, s[28:31], m0 offen offset:1024 sc1 lds
  buffer_load_dwordx4 v3, s[28:31], m0 offen offset:2048 sc1 lds
  buffer_load_dwordx4 a[4:7], v3, s[24:27], s45 offen offset:1024 sc1
  buffer_load_dwordx4 a[8:11], v3, s[24:27], s45 offen offset:2048 sc1
  buffer_load_dwordx4 a[12:15], v3, s[24:27], s45 offen offset:3072 sc1
  s_add_u32 s45, s45, 4096
  s_add_u32 m0, s47, 12288
  buffer_load_dwordx4 a[16:19], v3, s[24:27], s45 offen sc1
  buffer_load_dwordx4 v3, s[28:31], m0 offen offset:0 sc1 lds
  buffer_load_dwordx4 v3, s[28:31], m0 offen offset:1024 sc1 lds
  buffer_load_dwordx4 v3, s[28:31], m0 offen offset:2048 sc1 lds
  buffer_load_dwordx4 a[20:23], v3, s[24:27], s45 offen offset:1024 sc1
  buffer_load_dwordx4 a[24:27], v3, s[24:27], s45 offen offset:2048 sc1
  buffer_load_dwordx4 a[28:31], v3, s[24:27], s45 offen offset:3072 sc1
  s_add_u32 s45, s45, 4096
  s_waitcnt vmcnt(7)
  s_barrier
  ds_read_b128 v[24:27], v3 offset:0
  ds_read_b128 v[28:31], v3 offset:1024
  ds_read_b128 v[32:35], v3 offset:2048
  ds_read_b128 v[36:39], v3 offset:3072
  s_waitcnt lgkmcnt(3)
  v_mfma_f32_32x32x16_bf16 v[64:79], v[24:27], a[0:3], 0
  s_add_u32 m0, s47, 24576
  buffer_load_dwordx4 a[32:35], v3, s[24:27], s45 offen sc1
  ds_read_b128 v[40:43], v3 offset:4096
  s_waitcnt lgkmcnt(3)
  v_mfma_f32_32x32x16_bf16 v[80:95], v[28:31], a[0:3], 0
  ds_read_b128 v[44:47], v3 offset:5120
  s_waitcnt lgkmcnt(3)
  v_mfma_f32_32x32x16_bf16 v[96:111], v[32:35], a[0:3], 0
  buffer_load_dwordx4 v3, s[28:31], m0 offen offset:0 sc1 lds
  ds_read_b128 v[24:27], v3 offset:6144
  s_waitcnt lgkmcnt(3)
  v_mfma_f32_32x32x16_bf16 v[64:79], v[36:39], a[4:7], v[64:79]
  ds_read_b64_tr_b16 a[160:161], v248 offset:0
  buffer_load_dwordx4 v3, s[28:31], m0 offen offset:1024 sc1 lds
  ds_read_b128 v[28:31], v3 offset:7168
  s_waitcnt lgkmcnt(4)
  v_mfma_f32_32x32x16_bf16 v[80:95], v[40:43], a[4:7], v[80:95]
  ds_read_b64_tr_b16 a[162:163], v248 offset:512
  ds_read_b128 v[32:35], v3 offset:8192
  s_waitcnt lgkmcnt(5)
  v_mfma_f32_32x32x16_bf16 v[96:111], v[44:47], a[4:7], v[96:111]
  ds_read_b64_tr_b16 a[164:165], v248 offset:4096
  buffer_load_dwordx4 v3, s[28:31], m0 offen offset:2048 sc1 lds
  ds_read_b128 v[36:39], v3 offset:9216
  s_waitcnt lgkmcnt(6)
  v_mfma_f32_32x32x16_bf16 v[64:79], v[24:27], a[8:11], v[64:79]
  ds_read_b64_tr_b16 a[166:167], v248 offset:4608
  buffer_load_dwordx4 a[36:39], v3, s[24:27], s45 offen offset:1024 sc1
  ds_read_b128 v[40:43], v3 offset:10240
  s_waitcnt lgkmcnt(6)
  v_mfma_f32_32x32x16_bf16 v[80:95], v[28:31], a[8:11], v[80:95]
  ds_read_b64_tr_b16 a[168:169], v248 offset:8192
  ds_read_b128 v[44:47], v3 offset:11264
  s_waitcnt lgkmcnt(6)
  v_mfma_f32_32x32x16_bf16 v[96:111], v[32:35], a[8:11], v[96:111]
  ds_read_b64_tr_b16 a[170:171], v248 offset:8704
  buffer_load_dwordx4 a[40:43], v3, s[24:27], s45 offen offset:2048 sc1
  s_waitcnt vmcnt(6)
  s_barrier
  ds_read_b128 v[24:27], v3 offset:12288
  s_waitcnt lgkmcnt(6)
  v_mfma_f32_32x32x16_bf16 v[64:79], v[36:39], a[12:15], v[64:79]
  ds_read_b64_tr_b16 a[172:173], v248 offset:12288
  buffer_load_dwordx4 a[44:47], v3, s[24:27], s45 offen offset:3072 sc1
  s_add_u32 s45, s45, 4096
  ds_read_b128 v[28:31], v3 offset:13312
  s_waitcnt lgkmcnt(6)
  v_mfma_f32_32x32x16_bf16 v[80:95], v[40:43], a[12:15], v[80:95]
  ds_read_b64_tr_b16 a[174:175], v248 offset:12800
  ds_read_b128 v[32:35], v3 offset:14336
  s_waitcnt lgkmcnt(6)
  v_mfma_f32_32x32x16_bf16 v[96:111], v[44:47], a[12:15], v[96:111]
  ds_read_b64_tr_b16 a[176:177], v248 offset:16384
  s_add_u32 m0, s47, 36864
  buffer_load_dwordx4 a[48:51], v3, s[24:27], s45 offen sc1
  ds_read_b128 v[36:39], v3 offset:15360
  s_waitcnt lgkmcnt(6)
  v_mfma_f32_32x32x16_bf16 v[64:79], v[24:27], a[16:19], v[64:79]
  ds_read_b64_tr_b16 a[178:179], v248 offset:16896
  buffer_load_dwordx4 v3, s[28:31], m0 offen offset:0 sc1 lds
  ds_read_b128 v[40:43], v3 offset:16384
  s_waitcnt lgkmcnt(6)
  v_mfma_f32_32x32x16_bf16 v[80:95], v[28:31], a[16:19], v[80:95]
  ds_read_b64_tr_b16 a[180:181], v249 offset:0
  ds_read_b128 v[44:47], v3 offset:17408
  s_waitcnt lgkmcnt(6)
  v_mfma_f32_32x32x16_bf16 v[96:111], v[32:35], a[16:19], v[96:111]
  ds_read_b64_tr_b16 a[182:183], v249 offset:512
  buffer_load_dwordx4 v3, s[28:31], m0 offen offset:1024 sc1 lds
  ds_read_b128 v[24:27], v3 offset:18432
  s_waitcnt lgkmcnt(6)
  v_mfma_f32_32x32x16_bf16 v[64:79], v[36:39], a[20:23], v[64:79]
  ds_read_b64_tr_b16 a[184:185], v249 offset:32
  buffer_load_dwordx4 v3, s[28:31], m0 offen offset:2048 sc1 lds
  ds_read_b128 v[28:31], v3 offset:19456
  s_waitcnt lgkmcnt(6)
  v_mfma_f32_32x32x16_bf16 v[80:95], v[40:43], a[20:23], v[80:95]
  ds_read_b64_tr_b16 a[186:187], v249 offset:544
  ds_read_b128 v[32:35], v3 offset:20480
  s_waitcnt lgkmcnt(6)
  v_mfma_f32_32x32x16_bf16 v[96:111], v[44:47], a[20:23], v[96:111]
  ds_read_b64_tr_b16 a[188:189], v249 offset:64
  buffer_load_dwordx4 a[52:55], v3, s[24:27], s45 offen offset:1024 sc1
  ds_read_b128 v[36:39], v3 offset:21504
  s_waitcnt lgkmcnt(6)
  v_mfma_f32_32x32x16_bf16 v[64:79], v[24:27], a[24:27], v[64:79]
  ds_read_b64_tr_b16 a[190:191], v249 offset:576
  buffer_load_dwordx4 a[56:59], v3, s[24:27], s45 offen offset:2048 sc1
  ds_read_b128 v[40:43], v3 offset:22528
  s_waitcnt lgkmcnt(6)
  v_mfma_f32_32x32x16_bf16 v[80:95], v[28:31], a[24:27], v[80:95]
  ds_read_b64_tr_b16 a[192:193], v249 offset:96
  ds_read_b128 v[44:47], v3 offset:23552
  s_waitcnt lgkmcnt(6)
  v_mfma_f32_32x32x16_bf16 v[96:111], v[32:35], a[24:27], v[96:111]
  ds_read_b64_tr_b16 a[194:195], v249 offset:608
  buffer_load_dwordx4 a[60:63], v3, s[24:27], s45 offen offset:3072 sc1
  s_add_u32 s45, s45, 4096
  s_waitcnt vmcnt(7)
  s_barrier
  ds_read_b128 v[24:27], v3 offset:24576
  s_waitcnt lgkmcnt(6)
  v_mfma_f32_32x32x16_bf16 v[64:79], v[36:39], a[28:31], v[64:79]
  s_add_u32 m0, s47, 49152
  buffer_load_dwordx4 a[64:67], v3, s[24:27], s45 offen sc1
  ds_read_b128 v[28:31], v3 offset:25600
  s_waitcnt lgkmcnt(5)
  v_mfma_f32_32x32x16_bf16 v[80:95], v[40:43], a[28:31], v[80:95]
  ds_read_b128 v[32:35], v3 offset:26624
  s_waitcnt lgkmcnt(4)
  v_mfma_f32_32x32x16_bf16 v[96:111], v[44:47], a[28:31], v[96:111]
  buffer_load_dwordx4 v3, s[28:31], m0 offen offset:0 sc1 lds
  ds_read_b128 v[36:39], v3 offset:27648
  s_waitcnt lgkmcnt(3)
  v_mfma_f32_32x32x16_bf16 v[64:79], v[24:27], a[32:35], v[64:79]
  buffer_load_dwordx4 v3, s[28:31], m0 offen offset:1024 sc1 lds
  ds_read_b128 v[40:43], v3 offset:28672
  s_waitcnt lgkmcnt(3)
  v_mfma_f32_32x32x16_bf16 v[80:95], v[28:31], a[32:35], v[80:95]
  ds_read_b128 v[44:47], v3 offset:29696
  s_waitcnt lgkmcnt(3)
  v_mfma_f32_32x32x16_bf16 v[96:111], v[32:35], a[32:35], v[96:111]
  buffer_load_dwordx4 v3, s[28:31], m0 offen offset:2048 sc1 lds
  ds_read_b128 v[24:27], v3 offset:30720
  s_waitcnt lgkmcnt(3)
  v_mfma_f32_32x32x16_bf16 v[64:79], v[36:39], a[36:39], v[64:79]
  buffer_load_dwordx4 a[68:71], v3, s[24:27], s45 offen offset:1024 sc1
  ds_read_b128 v[28:31], v3 offset:31744
  s_waitcnt lgkmcnt(3)
  v_mfma_f32_32x32x16_bf16 v[80:95], v[40:43], a[36:39], v[80:95]
  ds_read_b128 v[32:35], v3 offset:32768
  s_waitcnt lgkmcnt(3)
  v_mfma_f32_32x32x16_bf16 v[96:111], v[44:47], a[36:39], v[96:111]
  buffer_load_dwordx4 a[72:75], v3, s[24:27], s45 offen offset:2048 sc1
  ds_read_b128 v[36:39], v3 offset:33792
  s_waitcnt lgkmcnt(3)
  v_mfma_f32_32x32x16_bf16 v[64:79], v[24:27], a[40:43], v[64:79]
  buffer_load_dwordx4 a[76:79], v3, s[24:27], s45 offen offset:3072 sc1
  s_add_u32 s45, s45, 4096
  ds_read_b128 v[40:43], v3 offset:34816
  s_waitcnt lgkmcnt(3)
  v_mfma_f32_32x32x16_bf16 v[80:95], v[28:31], a[40:43], v[80:95]
  ds_read_b128 v[44:47], v3 offset:35840
  s_waitcnt lgkmcnt(3)
  v_mfma_f32_32x32x16_bf16 v[96:111], v[32:35], a[40:43], v[96:111]
  s_add_u32 m0, s47, 61440
  buffer_load_dwordx4 a[80:83], v3, s[24:27], s45 offen sc1
  s_waitcnt vmcnt(8)
  s_barrier
  ds_read_b128 v[24:27], v3 offset:36864
  s_waitcnt lgkmcnt(3)
  v_mfma_f32_32x32x16_bf16 v[64:79], v[36:39], a[44:47], v[64:79]
  buffer_load_dwordx4 v3, s[28:31], m0 offen offset:0 sc1 lds
  ds_read_b128 v[28:31], v3 offset:37888
  s_waitcnt lgkmcnt(3)
  v_mfma_f32_32x32x16_bf16 v[80:95], v[40:43], a[44:47], v[80:95]
  ds_read_b128 v[32:35], v3 offset:38912
  s_waitcnt lgkmcnt(3)
  v_mfma_f32_32x32x16_bf16 v[96:111], v[44:47], a[44:47], v[96:111]
  buffer_load_dwordx4 v3, s[28:31], m0 offen offset:1024 sc1 lds
  ds_read_b128 v[36:39], v3 offset:39936
  s_waitcnt lgkmcnt(3)
  v_mfma_f32_32x32x16_bf16 v[64:79], v[24:27], a[48:51], v[64:79]
  v_mfma_f32_16x16x32_bf16 v[244:247], v[240:243], a[160:163], 0
  v_mfma_f32_16x16x32_bf16 v[244:247], v[240:243], a[164:167], v[244:247]
  v_mfma_f32_16x16x32_bf16 v[244:247], v[240:243], a[168:171], v[244:247]
  v_mfma_f32_16x16x32_bf16 v[244:247], v[240:243], a[172:175], v[244:247]
  v_mfma_f32_16x16x32_bf16 v[244:247], v[240:243], a[176:179], v[244:247]
  buffer_load_dwordx4 v3, s[28:31], m0 offen offset:2048 sc1 lds
  ds_read_b128 v[40:43], v3 offset:40960
  s_waitcnt lgkmcnt(3)
  v_mfma_f32_32x32x16_bf16 v[80:95], v[28:31], a[48:51], v[80:95]
  ds_read_b128 v[44:47], v3 offset:41984
  s_waitcnt lgkmcnt(3)
  v_mfma_f32_32x32x16_bf16 v[96:111], v[32:35], a[48:51], v[96:111]
  buffer_load_dwordx4 a[84:87], v3, s[24:27], s45 offen offset:1024 sc1
  ds_read_b128 v[24:27], v3 offset:43008
  s_waitcnt lgkmcnt(3)
  v_mfma_f32_32x32x16_bf16 v[64:79], v[36:39], a[52:55], v[64:79]
  buffer_load_dwordx4 a[88:91], v3, s[24:27], s45 offen offset:2048 sc1
  ds_read_b128 v[28:31], v3 offset:44032
  s_waitcnt lgkmcnt(3)
  v_mfma_f32_32x32x16_bf16 v[80:95], v[40:43], a[52:55], v[80:95]
  ds_read_b128 v[32:35], v3 offset:45056
  s_waitcnt lgkmcnt(3)
  v_mfma_f32_32x32x16_bf16 v[96:111], v[44:47], a[52:55], v[96:111]
  buffer_load_dwordx4 a[92:95], v3, s[24:27], s45 offen offset:3072 sc1
  s_add_u32 s45, s45, 4096
  ds_read_b128 v[36:39], v3 offset:46080
  s_waitcnt lgkmcnt(3)
  v_mfma_f32_32x32x16_bf16 v[64:79], v[24:27], a[56:59], v[64:79]
  s_add_u32 m0, s47, 73728
  buffer_load_dwordx4 a[96:99], v3, s[24:27], s45 offen sc1
  ds_read_b128 v[40:43], v3 offset:47104
  s_waitcnt lgkmcnt(3)
  v_mfma_f32_32x32x16_bf16 v[80:95], v[28:31], a[56:59], v[80:95]
  ds_read_b128 v[44:47], v3 offset:48128
  s_waitcnt lgkmcnt(3)
  v_mfma_f32_32x32x16_bf16 v[96:111], v[32:35], a[56:59], v[96:111]
  buffer_load_dwordx4 v3, s[28:31], m0 offen offset:0 sc1 lds
  s_waitcnt vmcnt(9)
  s_barrier
  ds_read_b128 v[24:27], v3 offset:49152
  s_waitcnt lgkmcnt(3)
  v_mfma_f32_32x32x16_bf16 v[64:79], v[36:39], a[60:63], v[64:79]
  buffer_load_dwordx4 v3, s[28:31], m0 offen offset:1024 sc1 lds
  ds_read_b128 v[28:31], v3 offset:50176
  s_waitcnt lgkmcnt(3)
  v_mfma_f32_32x32x16_bf16 v[80:95], v[40:43], a[60:63], v[80:95]
  ds_read_b128 v[32:35], v3 offset:51200
  s_waitcnt lgkmcnt(3)
  v_mfma_f32_32x32x16_bf16 v[96:111], v[44:47], a[60:63], v[96:111]
  buffer_load_dwordx4 v3, s[28:31], m0 offen offset:2048 sc1 lds
  ds_read_b128 v[36:39], v3 offset:52224
  s_waitcnt lgkmcnt(3)
  v_mfma_f32_32x32x16_bf16 v[64:79], v[24:27], a[64:67], v[64:79]
  v_cvt_pk_bf16_f32 v236, v244, v244
  buffer_load_dwordx4 a[100:103], v3, s[24:27], s45 offen offset:1024 sc1
  ds_read_b128 v[40:43], v3 offset:53248
  s_waitcnt lgkmcnt(3)
  v_mfma_f32_32x32x16_bf16 v[80:95], v[28:31], a[64:67], v[80:95]
  v_lshlrev_b32 v245, 16, v236
  ds_read_b128 v[44:47], v3 offset:54272
  s_waitcnt lgkmcnt(3)
  v_mfma_f32_32x32x16_bf16 v[96:111], v[32:35], a[64:67], v[96:111]
  v_sub_f32 v245, v244, v245
  buffer_load_dwordx4 a[104:107], v3, s[24:27], s45 offen offset:2048 sc1
  ds_read_b128 v[24:27], v3 offset:55296
  s_waitcnt lgkmcnt(3)
  v_mfma_f32_32x32x16_bf16 v[64:79], v[36:39], a[68:71], v[64:79]
  v_cvt_pk_bf16_f32 v237, v245, v245
  buffer_load_dwordx4 a[108:111], v3, s[24:27], s45 offen offset:3072 sc1
  s_add_u32 s45, s45, 4096
  ds_read_b128 v[28:31], v3 offset:56320
  s_waitcnt lgkmcnt(3)
  v_mfma_f32_32x32x16_bf16 v[80:95], v[40:43], a[68:71], v[80:95]
  ds_read_b128 v[32:35], v3 offset:57344
  s_waitcnt lgkmcnt(3)
  v_mfma_f32_32x32x16_bf16 v[96:111], v[44:47], a[68:71], v[96:111]
  s_add_u32 m0, s47, 86016
  buffer_load_dwordx4 a[112:115], v3, s[24:27], s45 offen sc1
  ds_read_b128 v[36:39], v3 offset:58368
  s_waitcnt lgkmcnt(3)
  v_mfma_f32_32x32x16_bf16 v[64:79], v[24:27], a[72:75], v[64:79]
  buffer_load_dwordx4 v3, s[28:31], m0 offen offset:0 sc1 lds
  ds_read_b128 v[40:43], v3 offset:59392
  s_waitcnt lgkmcnt(3)
  v_mfma_f32_32x32x16_bf16 v[80:95], v[28:31], a[72:75], v[80:95]
  ds_read_b128 v[44:47], v3 offset:60416
  s_waitcnt lgkmcnt(3)
  v_mfma_f32_32x32x16_bf16 v[96:111], v[32:35], a[72:75], v[96:111]
  buffer_load_dwordx4 v3, s[28:31], m0 offen offset:1024 sc1 lds
  s_waitcnt vmcnt(10)
  s_barrier
  ds_read_b128 v[24:27], v7 offset:0
  s_waitcnt lgkmcnt(3)
  v_mfma_f32_32x32x16_bf16 v[64:79], v[36:39], a[76:79], v[64:79]
  buffer_load_dwordx4 v3, s[28:31], m0 offen offset:2048 sc1 lds
  ds_read_b128 v[28:31], v7 offset:1024
  s_waitcnt lgkmcnt(3)
  v_mfma_f32_32x32x16_bf16 v[80:95], v[40:43], a[76:79], v[80:95]
  ds_read_b128 v[32:35], v7 offset:2048
  s_waitcnt lgkmcnt(3)
  v_mfma_f32_32x32x16_bf16 v[96:111], v[44:47], a[76:79], v[96:111]
  buffer_load_dwordx4 a[116:119], v3, s[24:27], s45 offen offset:1024 sc1
  ds_read_b128 v[36:39], v7 offset:3072
  s_waitcnt lgkmcnt(3)
  v_mfma_f32_32x32x16_bf16 v[64:79], v[24:27], a[80:83], v[64:79]
  buffer_load_dwordx4 a[120:123], v3, s[24:27], s45 offen offset:2048 sc1
  ds_read_b128 v[40:43], v7 offset:4096
  s_waitcnt lgkmcnt(3)
  v_mfma_f32_32x32x16_bf16 v[80:95], v[28:31], a[80:83], v[80:95]
  ds_read_b128 v[44:47], v7 offset:5120
  s_waitcnt lgkmcnt(3)
  v_mfma_f32_32x32x16_bf16 v[96:111], v[32:35], a[80:83], v[96:111]
  buffer_load_dwordx4 a[124:127], v3, s[24:27], s45 offen offset:3072 sc1
  s_add_u32 s45, s45, 4096
  ds_read_b128 v[24:27], v7 offset:6144
  s_waitcnt lgkmcnt(3)
  v_mfma_f32_32x32x16_bf16 v[64:79], v[36:39], a[84:87], v[64:79]
  s_add_u32 m0, s47, 98304
  buffer_load_dwordx4 a[128:131], v3, s[24:27], s45 offen sc1
  ds_read_b128 v[28:31], v7 offset:7168
  s_waitcnt lgkmcnt(3)
  v_mfma_f32_32x32x16_bf16 v[80:95], v[40:43], a[84:87], v[80:95]
  ds_read_b128 v[32:35], v7 offset:8192
  s_waitcnt lgkmcnt(3)
  v_mfma_f32_32x32x16_bf16 v[96:111], v[44:47], a[84:87], v[96:111]
  buffer_load_dwordx4 v3, s[28:31], m0 offen offset:0 sc1 lds
  ds_read_b128 v[36:39], v7 offset:9216
  s_waitcnt lgkmcnt(3)
  v_mfma_f32_32x32x16_bf16 v[64:79], v[24:27], a[88:91], v[64:79]
  buffer_load_dwordx4 v3, s[28:31], m0 offen offset:1024 sc1 lds
  ds_read_b128 v[40:43], v7 offset:10240
  s_waitcnt lgkmcnt(3)
  v_mfma_f32_32x32x16_bf16 v[80:95], v[28:31], a[88:91], v[80:95]
  ds_read_b128 v[44:47], v7 offset:11264
  s_waitcnt lgkmcnt(3)
  v_mfma_f32_32x32x16_bf16 v[96:111], v[32:35], a[88:91], v[96:111]
  buffer_load_dwordx4 v3, s[28:31], m0 offen offset:2048 sc1 lds
  s_waitcnt vmcnt(11)
  s_barrier
  ds_read_b128 v[24:27], v7 offset:12288
  s_waitcnt lgkmcnt(3)
  v_mfma_f32_32x32x16_bf16 v[64:79], v[36:39], a[92:95], v[64:79]
  buffer_load_dwordx4 a[132:135], v3, s[24:27], s45 offen offset:1024 sc1
  ds_read_b128 v[28:31], v7 offset:13312
  s_waitcnt lgkmcnt(3)
  v_mfma_f32_32x32x16_bf16 v[80:95], v[40:43], a[92:95], v[80:95]
  ds_read_b128 v[32:35], v7 offset:14336
  s_waitcnt lgkmcnt(3)
  v_mfma_f32_32x32x16_bf16 v[96:111], v[44:47], a[92:95], v[96:111]
  buffer_load_dwordx4 a[136:139], v3, s[24:27], s45 offen offset:2048 sc1
  ds_read_b128 v[36:39], v7 offset:15360
  s_waitcnt lgkmcnt(3)
  v_mfma_f32_32x32x16_bf16 v[64:79], v[24:27], a[96:99], v[64:79]
  buffer_load_dwordx4 a[140:143], v3, s[24:27], s45 offen offset:3072 sc1
  s_add_u32 s45, s45, 4096
  ds_read_b128 v[40:43], v7 offset:16384
  s_waitcnt lgkmcnt(3)
  v_mfma_f32_32x32x16_bf16 v[80:95], v[28:31], a[96:99], v[80:95]
  ds_read_b128 v[44:47], v7 offset:17408
  s_waitcnt lgkmcnt(3)
  v_mfma_f32_32x32x16_bf16 v[96:111], v[32:35], a[96:99], v[96:111]
  s_add_u32 m0, s47, 110592
  buffer_load_dwordx4 a[144:147], v3, s[24:27], s45 offen sc1
  ds_read_b128 v[24:27], v7 offset:18432
  s_waitcnt lgkmcnt(3)
  v_mfma_f32_32x32x16_bf16 v[64:79], v[36:39], a[100:103], v[64:79]
  buffer_load_dwordx4 v3, s[28:31], m0 offen offset:0 sc1 lds
  ds_read_b128 v[28:31], v7 offset:19456
  s_waitcnt lgkmcnt(3)
  v_mfma_f32_32x32x16_bf16 v[80:95], v[40:43], a[100:103], v[80:95]
  ds_read_b128 v[32:35], v7 offset:20480
  s_waitcnt lgkmcnt(3)
  v_mfma_f32_32x32x16_bf16 v[96:111], v[44:47], a[100:103], v[96:111]
  buffer_load_dwordx4 v3, s[28:31], m0 offen offset:1024 sc1 lds
  ds_read_b128 v[36:39], v7 offset:21504
  s_waitcnt lgkmcnt(3)
  v_mfma_f32_32x32x16_bf16 v[64:79], v[24:27], a[104:107], v[64:79]
  buffer_load_dwordx4 v3, s[28:31], m0 offen offset:2048 sc1 lds
  ds_read_b128 v[40:43], v7 offset:22528
  s_waitcnt lgkmcnt(3)
  v_mfma_f32_32x32x16_bf16 v[80:95], v[28:31], a[104:107], v[80:95]
  ds_read_b128 v[44:47], v7 offset:23552
  s_waitcnt lgkmcnt(3)
  v_mfma_f32_32x32x16_bf16 v[96:111], v[32:35], a[104:107], v[96:111]
  buffer_load_dwordx4 a[148:151], v3, s[24:27], s45 offen offset:1024 sc1
  s_waitcnt vmcnt(12)
  s_barrier
  ds_read_b128 v[24:27], v7 offset:24576
  s_waitcnt lgkmcnt(3)
  v_mfma_f32_32x32x16_bf16 v[64:79], v[36:39], a[108:111], v[64:79]
  buffer_load_dwordx4 a[152:155], v3, s[24:27], s45 offen offset:2048 sc1
  ds_read_b128 v[28:31], v7 offset:25600
  s_waitcnt lgkmcnt(3)
  v_mfma_f32_32x32x16_bf16 v[80:95], v[40:43], a[108:111], v[80:95]
  ds_read_b128 v[32:35], v7 offset:26624
  s_waitcnt lgkmcnt(3)
  v_mfma_f32_32x32x16_bf16 v[96:111], v[44:47], a[108:111], v[96:111]
  buffer_load_dwordx4 a[156:159], v3, s[24:27], s45 offen offset:3072 sc1
  ds_read_b128 v[36:39], v7 offset:27648
  s_waitcnt lgkmcnt(3)
  v_mfma_f32_32x32x16_bf16 v[64:79], v[24:27], a[112:115], v[64:79]
  s_add_u32 m0, s48, 122880
  s_nop 0
  buffer_load_dwordx4 v3, s[28:31], m0 offen offset:0 sc1 lds
  ds_read_b128 v[40:43], v7 offset:28672
  s_waitcnt lgkmcnt(3)
  v_mfma_f32_32x32x16_bf16 v[80:95], v[28:31], a[112:115], v[80:95]
  ds_read_b128 v[44:47], v7 offset:29696
  s_waitcnt lgkmcnt(3)
  v_mfma_f32_32x32x16_bf16 v[96:111], v[32:35], a[112:115], v[96:111]
  buffer_load_dwordx4 v3, s[28:31], m0 offen offset:1024 sc1 lds
  ds_read_b128 v[24:27], v7 offset:30720
  s_waitcnt lgkmcnt(3)
  v_mfma_f32_32x32x16_bf16 v[64:79], v[36:39], a[116:119], v[64:79]
  buffer_load_dwordx4 v3, s[28:31], m0 offen offset:2048 sc1 lds
  ds_read_b128 v[28:31], v7 offset:31744
  s_waitcnt lgkmcnt(3)
  v_mfma_f32_32x32x16_bf16 v[80:95], v[40:43], a[116:119], v[80:95]
  ds_read_b128 v[32:35], v7 offset:32768
  s_waitcnt lgkmcnt(3)
  v_mfma_f32_32x32x16_bf16 v[96:111], v[44:47], a[116:119], v[96:111]
  buffer_load_dwordx4 v3, s[28:31], m0 offen offset:3072 sc1 lds
  ds_read_b128 v[36:39], v7 offset:33792
  s_waitcnt lgkmcnt(3)
  v_mfma_f32_32x32x16_bf16 v[64:79], v[24:27], a[120:123], v[64:79]
  s_add_u32 m0, s48, 126976
  s_nop 0
  buffer_load_dwordx4 v3, s[28:31], m0 offen offset:0 sc1 lds
  ds_read_b128 v[40:43], v7 offset:34816
  s_waitcnt lgkmcnt(3)
  v_mfma_f32_32x32x16_bf16 v[80:95], v[28:31], a[120:123], v[80:95]
  ds_read_b128 v[44:47], v7 offset:35840
  s_waitcnt lgkmcnt(3)
  v_mfma_f32_32x32x16_bf16 v[96:111], v[32:35], a[120:123], v[96:111]
  buffer_load_dwordx4 v3, s[28:31], m0 offen offset:1024 sc1 lds
  s_waitcnt vmcnt(13)
  s_barrier
  ds_read_b128 v[24:27], v7 offset:36864
  s_waitcnt lgkmcnt(3)
  v_mfma_f32_32x32x16_bf16 v[64:79], v[36:39], a[124:127], v[64:79]
  buffer_load_dwordx4 v3, s[28:31], m0 offen offset:2048 sc1 lds
  ds_read_b128 v[28:31], v7 offset:37888
  s_waitcnt lgkmcnt(3)
  v_mfma_f32_32x32x16_bf16 v[80:95], v[40:43], a[124:127], v[80:95]
  ds_read_b128 v[32:35], v7 offset:38912
  s_waitcnt lgkmcnt(3)
  v_mfma_f32_32x32x16_bf16 v[96:111], v[44:47], a[124:127], v[96:111]
  buffer_load_dwordx4 v3, s[28:31], m0 offen offset:3072 sc1 lds
  ds_read_b128 v[36:39], v7 offset:39936
  s_waitcnt lgkmcnt(3)
  v_mfma_f32_32x32x16_bf16 v[64:79], v[24:27], a[128:131], v[64:79]
  s_add_u32 m0, s47, 61440
  s_nop 0
  buffer_load_dwordx4 v16, s[68:71], s56 offen nt lds
  ds_read_b128 v[40:43], v7 offset:40960
  s_waitcnt lgkmcnt(3)
  v_mfma_f32_32x32x16_bf16 v[80:95], v[28:31], a[128:131], v[80:95]
  ds_read_b128 v[44:47], v7 offset:41984
  s_waitcnt lgkmcnt(3)
  v_mfma_f32_32x32x16_bf16 v[96:111], v[32:35], a[128:131], v[96:111]
  s_add_u32 m0, s47, 62464
  s_nop 0
  buffer_load_dwordx4 v17, s[68:71], s56 offen nt lds
  ds_read_b128 v[24:27], v7 offset:43008
  s_waitcnt lgkmcnt(3)
  v_mfma_f32_32x32x16_bf16 v[64:79], v[36:39], a[132:135], v[64:79]
  s_add_u32 m0, s47, 63488
  s_nop 0
  buffer_load_dwordx4 v18, s[68:71], s56 offen nt lds
  ds_read_b128 v[28:31], v7 offset:44032
  s_waitcnt lgkmcnt(3)
  v_mfma_f32_32x32x16_bf16 v[80:95], v[40:43], a[132:135], v[80:95]
  ds_read_b128 v[32:35], v7 offset:45056
  s_waitcnt lgkmcnt(3)
  v_mfma_f32_32x32x16_bf16 v[96:111], v[44:47], a[132:135], v[96:111]
  ds_read_b128 v[36:39], v7 offset:46080
  s_waitcnt lgkmcnt(3)
  v_mfma_f32_32x32x16_bf16 v[64:79], v[24:27], a[136:139], v[64:79]
  buffer_store_dwordx4 a[180:183], v3, s[16:19], s97 offen sc1
  s_add_u32 s97, s97, s96
  ds_read_b128 v[40:43], v7 offset:47104
  s_waitcnt lgkmcnt(3)
  v_mfma_f32_32x32x16_bf16 v[80:95], v[28:31], a[136:139], v[80:95]
  ds_read_b128 v[44:47], v7 offset:48128
  s_waitcnt lgkmcnt(3)
  v_mfma_f32_32x32x16_bf16 v[96:111], v[32:35], a[136:139], v[96:111]
  buffer_store_dwordx4 a[184:187], v3, s[16:19], s97 offen sc1
  s_add_u32 s97, s97, s96
  s_waitcnt vmcnt(13)
  s_barrier
  ds_read_b128 v[24:27], v7 offset:49152
  s_waitcnt lgkmcnt(3)
  v_mfma_f32_32x32x16_bf16 v[64:79], v[36:39], a[140:143], v[64:79]
  buffer_store_dwordx4 a[188:191], v3, s[16:19], s97 offen sc1
  s_add_u32 s97, s97, s96
  ds_read_b128 v[28:31], v7 offset:50176
  s_waitcnt lgkmcnt(3)
  v_mfma_f32_32x32x16_bf16 v[80:95], v[40:43], a[140:143], v[80:95]
  ds_read_b128 v[32:35], v7 offset:51200
  s_waitcnt lgkmcnt(3)
  v_mfma_f32_32x32x16_bf16 v[96:111], v[44:47], a[140:143], v[96:111]
  buffer_store_dwordx4 a[192:195], v3, s[16:19], s97 offen sc1
  s_add_u32 s97, s97, s96
  ds_read_b128 v[36:39], v7 offset:52224
  s_waitcnt lgkmcnt(3)
  v_mfma_f32_32x32x16_bf16 v[64:79], v[24:27], a[144:147], v[64:79]
  ds_read_b128 v[40:43], v7 offset:53248
  s_waitcnt lgkmcnt(3)
  v_mfma_f32_32x32x16_bf16 v[80:95], v[28:31], a[144:147], v[80:95]
  ds_read_b128 v[44:47], v7 offset:54272
  s_waitcnt lgkmcnt(3)
  v_mfma_f32_32x32x16_bf16 v[96:111], v[32:35], a[144:147], v[96:111]
  ds_read_b128 v[24:27], v7 offset:55296
  s_waitcnt lgkmcnt(3)
  v_mfma_f32_32x32x16_bf16 v[64:79], v[36:39], a[148:151], v[64:79]
  ds_read_b128 v[28:31], v7 offset:56320
  s_waitcnt lgkmcnt(3)
  v_mfma_f32_32x32x16_bf16 v[80:95], v[40:43], a[148:151], v[80:95]
  ds_read_b128 v[32:35], v7 offset:57344
  s_waitcnt lgkmcnt(3)
  v_mfma_f32_32x32x16_bf16 v[96:111], v[44:47], a[148:151], v[96:111]
  ds_read_b128 v[36:39], v7 offset:58368
  s_waitcnt lgkmcnt(3)
  v_mfma_f32_32x32x16_bf16 v[64:79], v[24:27], a[152:155], v[64:79]
  ds_read_b128 v[40:43], v7 offset:59392
  s_waitcnt lgkmcnt(3)
  v_mfma_f32_32x32x16_bf16 v[80:95], v[28:31], a[152:155], v[80:95]
  ds_read_b128 v[44:47], v7 offset:60416
  s_waitcnt lgkmcnt(3)
  v_mfma_f32_32x32x16_bf16 v[96:111], v[32:35], a[152:155], v[96:111]
  s_waitcnt lgkmcnt(2)
  v_mfma_f32_32x32x16_bf16 v[64:79], v[36:39], a[156:159], v[64:79]
  s_waitcnt lgkmcnt(1)
  v_mfma_f32_32x32x16_bf16 v[80:95], v[40:43], a[156:159], v[80:95]
  s_waitcnt lgkmcnt(0)
  v_mfma_f32_32x32x16_bf16 v[96:111], v[44:47], a[156:159], v[96:111]
  s_nop 9
  v_cvt_pk_bf16_f32 v188, v84, v85
  v_cvt_pk_bf16_f32 v189, v86, v87
  v_cvt_pk_bf16_f32 v190, v88, v89
  v_cvt_pk_bf16_f32 v191, v90, v91
  v_cvt_pk_bf16_f32 v192, v92, v93
  v_cvt_pk_bf16_f32 v193, v94, v95
  v_cvt_pk_bf16_f32 v194, v96, v97
  v_cvt_pk_bf16_f32 v195, v98, v99
  v_cvt_pk_bf16_f32 v196, v100, v101
  v_mov_b32 v197, 0x3f80
  v_cvt_pk_bf16_f32 v198, v102, v103
  v_mov_b32 v199, 0x3f80
  v_max3_f32 v12, v64, v65, v66
  v_min3_f32 v14, v64, v65, v66
  v_max3_f32 v12, v12, v67, v68
  v_min3_f32 v14, v14, v67, v68
  v_max3_f32 v12, v12, v69, v70
  v_min3_f32 v14, v14, v69, v70
  v_max3_f32 v12, v12, v71, v72
  v_min3_f32 v14, v14, v71, v72
  v_max3_f32 v12, v12, v73, v74
  v_min3_f32 v14, v14, v73, v74
  ds_write_b128 v11, v[188:191] offset:80
  v_max3_f32 v12, v12, v75, v76
  v_min3_f32 v14, v14, v75, v76
  v_max3_f32 v12, v12, v77, v78
  v_min3_f32 v14, v14, v77, v78
  v_max3_f32 v12, v12, v79, v80
  v_min3_f32 v14, v14, v79, v80
  v_max3_f32 v12, v12, v81, v82
  v_min3_f32 v14, v14, v81, v82
  v_max_f32 v12, v12, v83
  v_min_f32 v14, v14, v83
  v_pk_add_f32 v[128:129], v[64:65], v[12:13] op_sel_hi:[1,0] neg_lo:[0,1] neg_hi:[0,1]
  v_pk_add_f32 v[148:149], v[64:65], v[14:15] op_sel_hi:[1,0] neg_lo:[1,0] neg_hi:[1,0]
  v_pk_add_f32 v[130:131], v[66:67], v[12:13] op_sel_hi:[1,0] neg_lo:[0,1] neg_hi:[0,1]
  v_pk_add_f32 v[150:151], v[66:67], v[14:15] op_sel_hi:[1,0] neg_lo:[1,0] neg_hi:[1,0]
  v_pk_add_f32 v[132:133], v[68:69], v[12:13] op_sel_hi:[1,0] neg_lo:[0,1] neg_hi:[0,1]
  v_pk_add_f32 v[152:153], v[68:69], v[14:15] op_sel_hi:[1,0] neg_lo:[1,0] neg_hi:[1,0]
  v_pk_add_f32 v[134:135], v[70:71], v[12:13] op_sel_hi:[1,0] neg_lo:[0,1] neg_hi:[0,1]
  v_pk_add_f32 v[154:155], v[70:71], v[14:15] op_sel_hi:[1,0] neg_lo:[1,0] neg_hi:[1,0]
  v_pk_add_f32 v[136:137], v[72:73], v[12:13] op_sel_hi:[1,0] neg_lo:[0,1] neg_hi:[0,1]
  v_pk_add_f32 v[156:157], v[72:73], v[14:15] op_sel_hi:[1,0] neg_lo:[1,0] neg_hi:[1,0]
  ds_write_b128 v11, v[192:195] offset:96
  v_pk_add_f32 v[138:139], v[74:75], v[12:13] op_sel_hi:[1,0] neg_lo:[0,1] neg_hi:[0,1]
  v_pk_add_f32 v[158:159], v[74:75], v[14:15] op_sel_hi:[1,0] neg_lo:[1,0] neg_hi:[1,0]
  v_pk_add_f32 v[140:141], v[76:77], v[12:13] op_sel_hi:[1,0] neg_lo:[0,1] neg_hi:[0,1]
  v_pk_add_f32 v[160:161], v[76:77], v[14:15] op_sel_hi:[1,0] neg_lo:[1,0] neg_hi:[1,0]
  v_pk_add_f32 v[142:143], v[78:79], v[12:13] op_sel_hi:[1,0] neg_lo:[0,1] neg_hi:[0,1]
  v_pk_add_f32 v[162:163], v[78:79], v[14:15] op_sel_hi:[1,0] neg_lo:[1,0] neg_hi:[1,0]
  v_pk_add_f32 v[144:145], v[80:81], v[12:13] op_sel_hi:[1,0] neg_lo:[0,1] neg_hi:[0,1]
  v_pk_add_f32 v[164:165], v[80:81], v[14:15] op_sel_hi:[1,0] neg_lo:[1,0] neg_hi:[1,0]
  v_pk_add_f32 v[146:147], v[82:83], v[12:13] op_sel_hi:[1,0] neg_lo:[0,1] neg_hi:[0,1]
  v_pk_add_f32 v[166:167], v[82:83], v[14:15] op_sel_hi:[1,0] neg_lo:[1,0] neg_hi:[1,0]
  v_exp_f32 v128, v128
  v_exp_f32 v129, v129
  v_exp_f32 v130, v130
  v_exp_f32 v131, v131
  v_exp_f32 v132, v132
  v_exp_f32 v133, v133
  v_exp_f32 v134, v134
  v_exp_f32 v135, v135
  v_exp_f32 v136, v136
  v_exp_f32 v137, v137
  ds_write_b128 v11, v[196:199] offset:112
  v_exp_f32 v138, v138
  v_exp_f32 v139, v139
  v_exp_f32 v140, v140
  v_exp_f32 v141, v141
  v_exp_f32 v142, v142
  v_exp_f32 v143, v143
  v_exp_f32 v144, v144
  v_exp_f32 v145, v145
  v_exp_f32 v146, v146
  v_exp_f32 v147, v147
  v_exp_f32 v148, v148
  v_exp_f32 v149, v149
  v_exp_f32 v150, v150
  v_exp_f32 v151, v151
  v_exp_f32 v152, v152
  v_exp_f32 v153, v153
  v_exp_f32 v154, v154
  v_exp_f32 v155, v155
  v_exp_f32 v156, v156
  v_exp_f32 v157, v157
  v_exp_f32 v158, v158
  v_exp_f32 v159, v159
  v_exp_f32 v160, v160
  v_exp_f32 v161, v161
  v_exp_f32 v162, v162
  v_exp_f32 v163, v163
  v_exp_f32 v164, v164
  v_exp_f32 v165, v165
  v_exp_f32 v166, v166
  v_exp_f32 v167, v167
  v_pk_add_f32 v[12:13], v[128:129], v[130:131]
  v_pk_add_f32 v[14:15], v[148:149], v[150:151]
  v_pk_add_f32 v[12:13], v[12:13], v[132:133]
  v_pk_add_f32 v[14:15], v[14:15], v[152:153]
  v_pk_add_f32 v[12:13], v[12:13], v[134:135]
  v_pk_add_f32 v[14:15], v[14:15], v[154:155]
  v_pk_add_f32 v[12:13], v[12:13], v[136:137]
  v_pk_add_f32 v[14:15], v[14:15], v[156:157]
  v_pk_add_f32 v[12:13], v[12:13], v[138:139]
  v_pk_add_f32 v[14:15], v[14:15], v[158:159]
  v_pk_add_f32 v[12:13], v[12:13], v[140:141]
  v_pk_add_f32 v[14:15], v[14:15], v[160:161]
  v_pk_add_f32 v[12:13], v[12:13], v[142:143]
  v_pk_add_f32 v[14:15], v[14:15], v[162:163]
  v_pk_add_f32 v[12:13], v[12:13], v[144:145]
  v_pk_add_f32 v[14:15], v[14:15], v[164:165]
  v_pk_add_f32 v[12:13], v[12:13], v[146:147]
  v_pk_add_f32 v[14:15], v[14:15], v[166:167]
  v_add_f32 v12, v12, v13
  v_add_f32 v14, v14, v15
  v_rcp_f32 v12, v12
  v_rcp_f32 v14, v14
  v_pk_mul_f32 v[128:129], v[128:129], v[12:13] op_sel_hi:[1,0]
  v_pk_mul_f32 v[130:131], v[130:131], v[12:13] op_sel_hi:[1,0]
  v_pk_mul_f32 v[132:133], v[132:133], v[12:13] op_sel_hi:[1,0]
  v_pk_mul_f32 v[134:135], v[134:135], v[12:13] op_sel_hi:[1,0]
  v_cvt_pk_bf16_f32 v168, v128, v129
  v_cvt_pk_bf16_f32 v169, v130, v131
  v_cvt_pk_bf16_f32 v170, v132, v133
  v_cvt_pk_bf16_f32 v171, v134, v135
  ds_write_b128 v11, v[168:171] offset:0
  v_pk_mul_f32 v[136:137], v[136:137], v[12:13] op_sel_hi:[1,0]
  v_pk_mul_f32 v[138:139], v[138:139], v[12:13] op_sel_hi:[1,0]
  v_pk_mul_f32 v[140:141], v[140:141], v[12:13] op_sel_hi:[1,0]
  v_pk_mul_f32 v[142:143], v[142:143], v[12:13] op_sel_hi:[1,0]
  v_cvt_pk_bf16_f32 v172, v136, v137
  v_cvt_pk_bf16_f32 v173, v138, v139
  v_cvt_pk_bf16_f32 v174, v140, v141
  v_cvt_pk_bf16_f32 v175, v142, v143
  ds_write_b128 v11, v[172:175] offset:16
  v_pk_mul_f32 v[144:145], v[144:145], v[12:13] op_sel_hi:[1,0]
  v_pk_mul_f32 v[146:147], v[146:147], v[12:13] op_sel_hi:[1,0]
  v_pk_mul_f32 v[148:149], v[148:149], v[14:15] op_sel_hi:[1,0]
  v_pk_mul_f32 v[150:151], v[150:151], v[14:15] op_sel_hi:[1,0]
  v_cvt_pk_bf16_f32 v176, v144, v145
  v_cvt_pk_bf16_f32 v177, v146, v147
  v_cvt_pk_bf16_f32 v178, v148, v149
  v_cvt_pk_bf16_f32 v179, v150, v151
  ds_write_b128 v11, v[176:179] offset:32
  v_pk_mul_f32 v[152:153], v[152:153], v[14:15] op_sel_hi:[1,0]
  v_pk_mul_f32 v[154:155], v[154:155], v[14:15] op_sel_hi:[1,0]
  v_pk_mul_f32 v[156:157], v[156:157], v[14:15] op_sel_hi:[1,0]
  v_pk_mul_f32 v[158:159], v[158:159], v[14:15] op_sel_hi:[1,0]
  v_cvt_pk_bf16_f32 v180, v152, v153
  v_cvt_pk_bf16_f32 v181, v154, v155
  v_cvt_pk_bf16_f32 v182, v156, v157
  v_cvt_pk_bf16_f32 v183, v158, v159
  ds_write_b128 v11, v[180:183] offset:48
  v_pk_mul_f32 v[160:161], v[160:161], v[14:15] op_sel_hi:[1,0]
  v_pk_mul_f32 v[162:163], v[162:163], v[14:15] op_sel_hi:[1,0]
  v_pk_mul_f32 v[164:165], v[164:165], v[14:15] op_sel_hi:[1,0]
  v_pk_mul_f32 v[166:167], v[166:167], v[14:15] op_sel_hi:[1,0]
  v_cvt_pk_bf16_f32 v184, v160, v161
  v_cvt_pk_bf16_f32 v185, v162, v163
  v_cvt_pk_bf16_f32 v186, v164, v165
  v_cvt_pk_bf16_f32 v187, v166, v167
  ds_write_b128 v11, v[184:187] offset:64
  s_waitcnt lgkmcnt(0)
  s_waitcnt vmcnt(7)
  s_barrier
  ds_read_b64_tr_b16 v[128:129], v57 offset:0
  ds_read_b64_tr_b16 v[200:201], v56 offset:80
  ds_read_b64_tr_b16 v[130:131], v57 offset:272
  ds_read_b64_tr_b16 v[202:203], v56 offset:352
  ds_read_b64_tr_b16 v[132:133], v57 offset:4352
  ds_read_b64_tr_b16 v[204:205], v56 offset:4432
  ds_read_b64_tr_b16 v[134:135], v57 offset:4624
  ds_read_b64_tr_b16 v[206:207], v56 offset:4704
  ds_read_b64_tr_b16 v[136:137], v57 offset:8704
  ds_read_b64_tr_b16 v[208:209], v56 offset:8784
  ds_read_b64_tr_b16 v[138:139], v57 offset:8976
  ds_read_b64_tr_b16 v[210:211], v56 offset:9056
  s_waitcnt lgkmcnt(8)
  v_mfma_f32_32x32x16_bf16 v[24:39], v[128:131], v[200:203], 0
  ds_read_b64_tr_b16 v[140:141], v57 offset:13056
  ds_read_b64_tr_b16 v[212:213], v56 offset:13136
  ds_read_b64_tr_b16 v[142:143], v57 offset:13328
  ds_read_b64_tr_b16 v[214:215], v56 offset:13408
  s_waitcnt lgkmcnt(8)
  v_mfma_f32_32x32x16_bf16 v[24:39], v[132:135], v[204:207], v[24:39]
  ds_read_b64_tr_b16 v[144:145], v57 offset:17408
  ds_read_b64_tr_b16 v[216:217], v56 offset:17488
  ds_read_b64_tr_b16 v[146:147], v57 offset:17680
  ds_read_b64_tr_b16 v[218:219], v56 offset:17760
  s_waitcnt lgkmcnt(8)
  v_mfma_f32_32x32x16_bf16 v[24:39], v[136:139], v[208:211], v[24:39]
  ds_read_b64_tr_b16 v[148:149], v57 offset:21760
  ds_read_b64_tr_b16 v[220:221], v56 offset:21840
  ds_read_b64_tr_b16 v[150:151], v57 offset:22032
  ds_read_b64_tr_b16 v[222:223], v56 offset:22112
  s_waitcnt lgkmcnt(8)
  v_mfma_f32_32x32x16_bf16 v[24:39], v[140:143], v[212:215], v[24:39]
  ds_read_b64_tr_b16 v[152:153], v57 offset:26112
  ds_read_b64_tr_b16 v[224:225], v56 offset:26192
  ds_read_b64_tr_b16 v[154:155], v57 offset:26384
  ds_read_b64_tr_b16 v[226:227], v56 offset:26464
  s_waitcnt lgkmcnt(8)
  v_mfma_f32_32x32x16_bf16 v[24:39], v[144:147], v[216:219], v[24:39]
  ds_read_b64_tr_b16 v[156:157], v57 offset:30464
  ds_read_b64_tr_b16 v[228:229], v56 offset:30544
  ds_read_b64_tr_b16 v[158:159], v57 offset:30736
  ds_read_b64_tr_b16 v[230:231], v56 offset:30816
  s_waitcnt lgkmcnt(8)
  v_mfma_f32_32x32x16_bf16 v[24:39], v[148:151], v[220:223], v[24:39]
  s_waitcnt lgkmcnt(4)
  v_mfma_f32_32x32x16_bf16 v[24:39], v[152:155], v[224:227], v[24:39]
  s_waitcnt lgkmcnt(0)
  v_mfma_f32_32x32x16_bf16 v[24:39], v[156:159], v[228:231], v[24:39]
  s_mov_b32 exec_lo, 0xffffff
  s_mov_b32 exec_hi, 0xffffff
  s_nop 9
  ds_write_b128 v58, v[24:27] offset:0
  ds_write_b128 v58, v[28:31] offset:768
  ds_write_b128 v58, v[32:35] offset:1536
  s_mov_b64 exec, -1
  ds_read_b32 v40, v59 offset:0
  ds_read_b32 v41, v59 offset:256
  ds_read_b32 v42, v59 offset:512
  ds_read_b32 v43, v59 offset:768
  ds_read_b32 v44, v59 offset:1024
  ds_read_b32 v45, v59 offset:1280
  ds_read_b32 v46, v59 offset:1536
  ds_read_b32 v47, v59 offset:1792
  ds_read_b128 v[128:131], v6 offset:0
  ds_read_b128 v[132:135], v6 offset:768
  ds_read_b128 v[136:139], v6 offset:1536
  ds_read_b128 v[140:143], v6 offset:2304
  ds_read_b128 v[144:147], v6 offset:3072
  ds_read_b128 v[148:151], v6 offset:3840
  s_waitcnt lgkmcnt(13)
  buffer_atomic_add_f32 v40, v60, s[36:39], s54 offen offset:0
  s_waitcnt lgkmcnt(12)
  buffer_atomic_add_f32 v41, v60, s[36:39], s54 offen offset:256
  s_waitcnt lgkmcnt(11)
  buffer_atomic_add_f32 v42, v60, s[36:39], s54 offen offset:512
  s_waitcnt lgkmcnt(10)
  buffer_atomic_add_f32 v43, v60, s[36:39], s54 offen offset:768
  s_waitcnt lgkmcnt(9)
  buffer_atomic_add_f32 v44, v60, s[36:39], s54 offen offset:1024
  s_waitcnt lgkmcnt(8)
  buffer_atomic_add_f32 v45, v60, s[36:39], s54 offen offset:1280
  s_waitcnt lgkmcnt(7)
  buffer_atomic_add_f32 v46, v60, s[36:39], s54 offen offset:1536
  s_waitcnt lgkmcnt(6)
  s_mov_b32 exec_hi, 0
  buffer_atomic_add_f32 v47, v60, s[36:39], s54 offen offset:1792
  s_mov_b64 exec, -1
  ds_read_b128 v[152:155], v6 offset:4608
  s_waitcnt lgkmcnt(5)
  v_mfma_f32_32x32x16_bf16 v[112:127], v[128:131], a[0:3], 0
  ds_read_b128 v[156:159], v6 offset:5376
  v_mfma_f32_32x32x16_bf16 v[112:127], v[132:135], a[4:7], v[112:127]
  ds_read_b128 v[160:163], v6 offset:6144
  s_waitcnt lgkmcnt(5)
  v_mfma_f32_32x32x16_bf16 v[112:127], v[136:139], a[8:11], v[112:127]
  ds_read_b128 v[164:167], v6 offset:6912
  v_mfma_f32_32x32x16_bf16 v[112:127], v[140:143], a[12:15], v[112:127]
  buffer_store_dwordx4 a[160:163], v238, s[12:15], s52 offen offset:0 sc1
  ds_read_b128 v[128:131], v6 offset:7680
  s_waitcnt lgkmcnt(5)
  v_mfma_f32_32x32x16_bf16 v[112:127], v[144:147], a[16:19], v[112:127]
  ds_read_b128 v[132:135], v6 offset:8448
  v_mfma_f32_32x32x16_bf16 v[112:127], v[148:151], a[20:23], v[112:127]
  ds_read_b128 v[136:139], v6 offset:9216
  s_waitcnt lgkmcnt(5)
  v_mfma_f32_32x32x16_bf16 v[112:127], v[152:155], a[24:27], v[112:127]
  ds_read_b128 v[140:143], v6 offset:9984
  v_mfma_f32_32x32x16_bf16 v[112:127], v[156:159], a[28:31], v[112:127]
  buffer_store_dwordx4 a[164:167], v238, s[12:15], s52 offen offset:1024 sc1
  ds_read_b128 v[144:147], v6 offset:10752
  s_waitcnt lgkmcnt(5)
  v_mfma_f32_32x32x16_bf16 v[112:127], v[160:163], a[32:35], v[112:127]
  ds_read_b128 v[148:151], v6 offset:11520
  v_mfma_f32_32x32x16_bf16 v[112:127], v[164:167], a[36:39], v[112:127]
  ds_read_b128 v[152:155], v6 offset:12288
  s_waitcnt lgkmcnt(5)
  v_mfma_f32_32x32x16_bf16 v[112:127], v[128:131], a[40:43], v[112:127]
  ds_read_b128 v[156:159], v6 offset:13056
  v_mfma_f32_32x32x16_bf16 v[112:127], v[132:135], a[44:47], v[112:127]
  buffer_store_dwordx4 a[168:171], v238, s[12:15], s52 offen offset:2048 sc1
  ds_read_b128 v[160:163], v6 offset:13824
  s_waitcnt lgkmcnt(5)
  v_mfma_f32_32x32x16_bf16 v[112:127], v[136:139], a[48:51], v[112:127]
  ds_read_b128 v[164:167], v6 offset:14592
  v_mfma_f32_32x32x16_bf16 v[112:127], v[140:143], a[52:55], v[112:127]
  ds_read_b128 v[128:131], v6 offset:15360
  s_waitcnt lgkmcnt(5)
  v_mfma_f32_32x32x16_bf16 v[112:127], v[144:147], a[56:59], v[112:127]
  ds_read_b128 v[132:135], v6 offset:16128
  v_mfma_f32_32x32x16_bf16 v[112:127], v[148:151], a[60:63], v[112:127]
  buffer_store_dwordx4 a[172:175], v238, s[12:15], s52 offen offset:3072 sc1
  ds_read_b128 v[136:139], v6 offset:16896
  s_waitcnt lgkmcnt(5)
  v_mfma_f32_32x32x16_bf16 v[112:127], v[152:155], a[64:67], v[112:127]
  ds_read_b128 v[140:143], v6 offset:17664
  v_mfma_f32_32x32x16_bf16 v[112:127], v[156:159], a[68:71], v[112:127]
  ds_read_b128 v[144:147], v6 offset:18432
  s_waitcnt lgkmcnt(5)
  v_mfma_f32_32x32x16_bf16 v[112:127], v[160:163], a[72:75], v[112:127]
  ds_read_b128 v[148:151], v6 offset:19200
  v_mfma_f32_32x32x16_bf16 v[112:127], v[164:167], a[76:79], v[112:127]
  buffer_store_dwordx4 a[176:179], v238, s[12:15], s53 offen offset:0 sc1
  ds_read_b128 v[152:155], v6 offset:19968
  s_waitcnt lgkmcnt(5)
  v_mfma_f32_32x32x16_bf16 v[112:127], v[128:131], a[80:83], v[112:127]
  ds_read_b128 v[156:159], v6 offset:20736
  v_mfma_f32_32x32x16_bf16 v[112:127], v[132:135], a[84:87], v[112:127]
  ds_read_b128 v[160:163], v6 offset:21504
  s_waitcnt lgkmcnt(5)
  v_mfma_f32_32x32x16_bf16 v[112:127], v[136:139], a[88:91], v[112:127]
  ds_read_b128 v[164:167], v6 offset:22272
  v_mfma_f32_32x32x16_bf16 v[112:127], v[140:143], a[92:95], v[112:127]
  buffer_store_dwordx2 v[236:237], v239, s[32:35], s58 offen sc1
  ds_read_b128 v[128:131], v6 offset:23040
  s_waitcnt lgkmcnt(5)
  v_mfma_f32_32x32x16_bf16 v[112:127], v[144:147], a[96:99], v[112:127]
  ds_read_b128 v[132:135], v6 offset:23808
  v_mfma_f32_32x32x16_bf16 v[112:127], v[148:151], a[100:103], v[112:127]
  ds_read_b128 v[136:139], v6 offset:24576
  s_waitcnt lgkmcnt(5)
  v_mfma_f32_32x32x16_bf16 v[112:127], v[152:155], a[104:107], v[112:127]
  ds_read_b128 v[140:143], v6 offset:25344
  v_mfma_f32_32x32x16_bf16 v[112:127], v[156:159], a[108:111], v[112:127]
  buffer_store_dwordx4 a[180:183], v3, s[16:19], s59 offen sc1
  s_add_u32 s59, s59, s96
  ds_read_b128 v[144:147], v6 offset:26112
  s_waitcnt lgkmcnt(5)
  v_mfma_f32_32x32x16_bf16 v[112:127], v[160:163], a[112:115], v[112:127]
  ds_read_b128 v[148:151], v6 offset:26880
  v_mfma_f32_32x32x16_bf16 v[112:127], v[164:167], a[116:119], v[112:127]
  ds_read_b128 v[152:155], v6 offset:27648
  s_waitcnt lgkmcnt(5)
  v_mfma_f32_32x32x16_bf16 v[112:127], v[128:131], a[120:123], v[112:127]
  ds_read_b128 v[156:159], v6 offset:28416
  v_mfma_f32_32x32x16_bf16 v[112:127], v[132:135], a[124:127], v[112:127]
  buffer_store_dwordx4 a[184:187], v3, s[16:19], s59 offen sc1
  s_add_u32 s59, s59, s96
  ds_read_b128 v[160:163], v6 offset:29184
  s_waitcnt lgkmcnt(5)
  v_mfma_f32_32x32x16_bf16 v[112:127], v[136:139], a[128:131], v[112:127]
  ds_read_b128 v[164:167], v6 offset:29952
  v_mfma_f32_32x32x16_bf16 v[112:127], v[140:143], a[132:135], v[112:127]
  s_waitcnt lgkmcnt(4)
  v_mfma_f32_32x32x16_bf16 v[112:127], v[144:147], a[136:139], v[112:127]
  v_mfma_f32_32x32x16_bf16 v[112:127], v[148:151], a[140:143], v[112:127]
  buffer_store_dwordx4 a[188:191], v3, s[16:19], s59 offen sc1
  s_add_u32 s59, s59, s96
  s_waitcnt lgkmcnt(2)
  v_mfma_f32_32x32x16_bf16 v[112:127], v[152:155], a[144:147], v[112:127]
  v_mfma_f32_32x32x16_bf16 v[112:127], v[156:159], a[148:151], v[112:127]
  s_waitcnt lgkmcnt(0)
  v_mfma_f32_32x32x16_bf16 v[112:127], v[160:163], a[152:155], v[112:127]
  v_mfma_f32_32x32x16_bf16 v[112:127], v[164:167], a[156:159], v[112:127]
  buffer_store_dwordx4 a[192:195], v3, s[16:19], s59 offen sc1
  s_add_u32 s59, s59, s96
  s_waitcnt vmcnt(10)
  s_barrier
  buffer_store_dword v19, v61, s[8:11], 0 offen sc0 sc1
  v_max3_f32 v12, v104, v105, v106
  v_min3_f32 v14, v104, v105, v106
  v_max3_f32 v12, v12, v107, v108
  v_min3_f32 v14, v14, v107, v108
  v_max3_f32 v12, v12, v109, v110
  v_min3_f32 v14, v14, v109, v110
  s_nop 0
  v_max3_f32 v12, v12, v111, v112
  v_min3_f32 v14, v14, v111, v112
  v_max3_f32 v12, v12, v113, v114
  v_min3_f32 v14, v14, v113, v114
  v_max3_f32 v12, v12, v115, v116
  v_min3_f32 v14, v14, v115, v116
  v_max3_f32 v12, v12, v117, v118
  v_min3_f32 v14, v14, v117, v118
  v_max3_f32 v12, v12, v119, v120
  v_min3_f32 v14, v14, v119, v120
  v_max3_f32 v12, v12, v121, v122
  v_min3_f32 v14, v14, v121, v122
  v_max_f32 v12, v12, v123
  v_min_f32 v14, v14, v123
  v_pk_add_f32 v[128:129], v[104:105], v[12:13] op_sel_hi:[1,0] neg_lo:[0,1] neg_hi:[0,1]
  v_pk_add_f32 v[148:149], v[104:105], v[14:15] op_sel_hi:[1,0] neg_lo:[1,0] neg_hi:[1,0]
  v_pk_add_f32 v[130:131], v[106:107], v[12:13] op_sel_hi:[1,0] neg_lo:[0,1] neg_hi:[0,1]
  v_pk_add_f32 v[150:151], v[106:107], v[14:15] op_sel_hi:[1,0] neg_lo:[1,0] neg_hi:[1,0]
  v_pk_add_f32 v[132:133], v[108:109], v[12:13] op_sel_hi:[1,0] neg_lo:[0,1] neg_hi:[0,1]
  v_pk_add_f32 v[152:153], v[108:109], v[14:15] op_sel_hi:[1,0] neg_lo:[1,0] neg_hi:[1,0]
  v_pk_add_f32 v[134:135], v[110:111], v[12:13] op_sel_hi:[1,0] neg_lo:[0,1] neg_hi:[0,1]
  v_pk_add_f32 v[154:155], v[110:111], v[14:15] op_sel_hi:[1,0] neg_lo:[1,0] neg_hi:[1,0]
  v_pk_add_f32 v[136:137], v[112:113], v[12:13] op_sel_hi:[1,0] neg_lo:[0,1] neg_hi:[0,1]
  v_pk_add_f32 v[156:157], v[112:113], v[14:15] op_sel_hi:[1,0] neg_lo:[1,0] neg_hi:[1,0]
  v_pk_add_f32 v[138:139], v[114:115], v[12:13] op_sel_hi:[1,0] neg_lo:[0,1] neg_hi:[0,1]
  v_pk_add_f32 v[158:159], v[114:115], v[14:15] op_sel_hi:[1,0] neg_lo:[1,0] neg_hi:[1,0]
  v_pk_add_f32 v[140:141], v[116:117], v[12:13] op_sel_hi:[1,0] neg_lo:[0,1] neg_hi:[0,1]
  v_pk_add_f32 v[160:161], v[116:117], v[14:15] op_sel_hi:[1,0] neg_lo:[1,0] neg_hi:[1,0]
  v_pk_add_f32 v[142:143], v[118:119], v[12:13] op_sel_hi:[1,0] neg_lo:[0,1] neg_hi:[0,1]
  v_pk_add_f32 v[162:163], v[118:119], v[14:15] op_sel_hi:[1,0] neg_lo:[1,0] neg_hi:[1,0]
  v_pk_add_f32 v[144:145], v[120:121], v[12:13] op_sel_hi:[1,0] neg_lo:[0,1] neg_hi:[0,1]
  v_pk_add_f32 v[164:165], v[120:121], v[14:15] op_sel_hi:[1,0] neg_lo:[1,0] neg_hi:[1,0]
  v_pk_add_f32 v[146:147], v[122:123], v[12:13] op_sel_hi:[1,0] neg_lo:[0,1] neg_hi:[0,1]
  v_pk_add_f32 v[166:167], v[122:123], v[14:15] op_sel_hi:[1,0] neg_lo:[1,0] neg_hi:[1,0]
  v_exp_f32 v128, v128
  v_exp_f32 v129, v129
  v_exp_f32 v130, v130
  v_exp_f32 v131, v131
  v_exp_f32 v132, v132
  v_exp_f32 v133, v133
  v_exp_f32 v134, v134
  v_exp_f32 v135, v135
  v_exp_f32 v136, v136
  v_exp_f32 v137, v137
  v_exp_f32 v138, v138
  v_exp_f32 v139, v139
  v_exp_f32 v140, v140
  v_exp_f32 v141, v141
  v_exp_f32 v142, v142
  v_exp_f32 v143, v143
  v_exp_f32 v144, v144
  v_exp_f32 v145, v145
  v_exp_f32 v146, v146
  v_exp_f32 v147, v147
  v_exp_f32 v148, v148
  v_exp_f32 v149, v149
  v_exp_f32 v150, v150
  v_exp_f32 v151, v151
  v_exp_f32 v152, v152
  v_exp_f32 v153, v153
  v_exp_f32 v154, v154
  v_exp_f32 v155, v155
  v_exp_f32 v156, v156
  v_exp_f32 v157, v157
  v_exp_f32 v158, v158
  v_exp_f32 v159, v159
  v_exp_f32 v160, v160
  v_exp_f32 v161, v161
  v_exp_f32 v162, v162
  v_exp_f32 v163, v163
  v_exp_f32 v164, v164
  v_exp_f32 v165, v165
  v_exp_f32 v166, v166
  v_exp_f32 v167, v167
  v_pk_add_f32 v[12:13], v[128:129], v[130:131]
  v_pk_add_f32 v[14:15], v[148:149], v[150:151]
  v_pk_add_f32 v[12:13], v[12:13], v[132:133]
  v_pk_add_f32 v[14:15], v[14:15], v[152:153]
  v_pk_add_f32 v[12:13], v[12:13], v[134:135]
  v_pk_add_f32 v[14:15], v[14:15], v[154:155]
  v_pk_add_f32 v[12:13], v[12:13], v[136:137]
  v_pk_add_f32 v[14:15], v[14:15], v[156:157]
  v_pk_add_f32 v[12:13], v[12:13], v[138:139]
  v_pk_add_f32 v[14:15], v[14:15], v[158:159]
  v_pk_add_f32 v[12:13], v[12:13], v[140:141]
  v_pk_add_f32 v[14:15], v[14:15], v[160:161]
  v_pk_add_f32 v[12:13], v[12:13], v[142:143]
  v_pk_add_f32 v[14:15], v[14:15], v[162:163]
  v_pk_add_f32 v[12:13], v[12:13], v[144:145]
  v_pk_add_f32 v[14:15], v[14:15], v[164:165]
  v_pk_add_f32 v[12:13], v[12:13], v[146:147]
  v_pk_add_f32 v[14:15], v[14:15], v[166:167]
  v_add_f32 v12, v12, v13
  v_add_f32 v14, v14, v15
  v_rcp_f32 v12, v12
  v_rcp_f32 v14, v14
  v_pk_mul_f32 v[128:129], v[128:129], v[12:13] op_sel_hi:[1,0]
  v_pk_mul_f32 v[148:149], v[148:149], v[14:15] op_sel_hi:[1,0]
  v_pk_mul_f32 v[130:131], v[130:131], v[12:13] op_sel_hi:[1,0]
  v_pk_mul_f32 v[150:151], v[150:151], v[14:15] op_sel_hi:[1,0]
  v_pk_mul_f32 v[132:133], v[132:133], v[12:13] op_sel_hi:[1,0]
  v_pk_mul_f32 v[152:153], v[152:153], v[14:15] op_sel_hi:[1,0]
  v_pk_mul_f32 v[134:135], v[134:135], v[12:13] op_sel_hi:[1,0]
  v_pk_mul_f32 v[154:155], v[154:155], v[14:15] op_sel_hi:[1,0]
  v_pk_mul_f32 v[136:137], v[136:137], v[12:13] op_sel_hi:[1,0]
  v_pk_mul_f32 v[156:157], v[156:157], v[14:15] op_sel_hi:[1,0]
  v_pk_mul_f32 v[138:139], v[138:139], v[12:13] op_sel_hi:[1,0]
  v_pk_mul_f32 v[158:159], v[158:159], v[14:15] op_sel_hi:[1,0]
  v_pk_mul_f32 v[140:141], v[140:141], v[12:13] op_sel_hi:[1,0]
  v_pk_mul_f32 v[160:161], v[160:161], v[14:15] op_sel_hi:[1,0]
  v_pk_mul_f32 v[142:143], v[142:143], v[12:13] op_sel_hi:[1,0]
  v_pk_mul_f32 v[162:163], v[162:163], v[14:15] op_sel_hi:[1,0]
  v_pk_mul_f32 v[144:145], v[144:145], v[12:13] op_sel_hi:[1,0]
  v_pk_mul_f32 v[164:165], v[164:165], v[14:15] op_sel_hi:[1,0]
  v_pk_mul_f32 v[146:147], v[146:147], v[12:13] op_sel_hi:[1,0]
  v_pk_mul_f32 v[166:167], v[166:167], v[14:15] op_sel_hi:[1,0]
  v_cvt_pk_bf16_f32 v168, v128, v129
  v_cvt_pk_bf16_f32 v169, v130, v131
  v_cvt_pk_bf16_f32 v170, v132, v133
  v_cvt_pk_bf16_f32 v171, v134, v135
  v_cvt_pk_bf16_f32 v172, v136, v137
  v_cvt_pk_bf16_f32 v173, v138, v139
  v_cvt_pk_bf16_f32 v174, v140, v141
  v_cvt_pk_bf16_f32 v175, v142, v143
  v_cvt_pk_bf16_f32 v176, v144, v145
  v_cvt_pk_bf16_f32 v177, v146, v147
  v_cvt_pk_bf16_f32 v178, v148, v149
  v_cvt_pk_bf16_f32 v179, v150, v151
  v_cvt_pk_bf16_f32 v180, v152, v153
  v_cvt_pk_bf16_f32 v181, v154, v155
  v_cvt_pk_bf16_f32 v182, v156, v157
  v_cvt_pk_bf16_f32 v183, v158, v159
  v_cvt_pk_bf16_f32 v184, v160, v161
  v_cvt_pk_bf16_f32 v185, v162, v163
  v_cvt_pk_bf16_f32 v186, v164, v165
  v_cvt_pk_bf16_f32 v187, v166, v167
  v_permlane32_swap_b32 v168, v172
  v_permlane32_swap_b32 v169, v173
  v_permlane32_swap_b32 v170, v174
  v_permlane32_swap_b32 v171, v175
  v_permlane32_swap_b32 v176, v180
  v_permlane32_swap_b32 v177, v181
  v_permlane32_swap_b32 v178, v182
  v_permlane32_swap_b32 v179, v183
  s_add_u32 s24, s20, 5111808
  s_addc_u32 s25, s21, 0
  s_mov_b32 s26, 122880
  s_mov_b32 s27, 0x20000
  s_add_u32 s28, s20, 20643840
  s_addc_u32 s29, s21, 0
  s_mov_b32 s30, 2621440
  s_mov_b32 s31, 0x20000
  v_min_u32 v6, 23, v5
  v_lshlrev_b32 v6, 4, v6
  v_mul_u32_u24 v7, 3840, v4
  v_add_u32 v7, v7, v6
  v_mul_u32_u24 v8, 768, v4
  v_add_u32 v6, v8, v6
  s_mul_i32 s45, s43, 7680
  s_add_u32 s46, s45, 3840
  v_and_b32 v8, 15, v2
  v_lshlrev_b32 v8, 4, v8
  s_lshl_b32 s47, s43, 8
  s_add_u32 s47, s47, 61440
  v_lshrrev_b32 v10, 4, v5
  v_mul_u32_u24 v10, 20480, v10
  v_add_u32 v10, v10, v8
  v_lshl_add_u32 v11, v4, 8, v10
  s_mul_i32 s48, s44, 40960
  s_mul_i32 s49, s43, 1280
  s_add_u32 s48, s48, s49
  s_lshl_b32 s49, s44, 4
  s_add_u32 s49, s49, s43
  s_lshl_b32 s49, s49, 4
  s_add_u32 s49, s49, 0
  v_mov_b32 v12, 0
  v_mov_b32 v13, 0
  v_mov_b32 v14, 0
  v_mov_b32 v15, 0
  v_mov_b32 v16, 0
  v_mov_b32 v17, 0
  v_mov_b32 v18, 0
  v_mov_b32 v19, 0
  s_mov_b32 s92, 0
M_poll2a:
  buffer_load_dword v9, v8, s[8:11], s47 offen sc1
  s_add_u32 s92, s92, 1
  s_cmp_gt_u32 s92, 400000
  s_cbranch_scc1 M_poll2a_go
  s_waitcnt vmcnt(0)
  v_cmp_ne_u32 vcc, s93, v9
  s_nop 4
  s_cbranch_vccnz M_poll2a
M_poll2a_go:
  s_waitcnt vmcnt(0)
  buffer_load_dwordx4 v[64:67], v6, s[24:27], s45 offen offset:0 sc1
  buffer_load_dwordx4 v[68:71], v6, s[24:27], s45 offen offset:384 sc1
  buffer_load_dwordx4 v[72:75], v6, s[24:27], s45 offen offset:1536 sc1
  buffer_load_dwordx4 v[76:79], v6, s[24:27], s45 offen offset:1920 sc1
  buffer_load_dwordx4 v[96:99], v7, s[24:27], s45 offen offset:3072 sc1
  buffer_load_dwordx4 v[100:103], v7, s[24:27], s45 offen offset:3456 sc1
  buffer_load_dwordx4 v[80:83], v6, s[24:27], s46 offen offset:0 sc1
  buffer_load_dwordx4 v[84:87], v6, s[24:27], s46 offen offset:384 sc1
  buffer_load_dwordx4 v[88:91], v6, s[24:27], s46 offen offset:1536 sc1
  buffer_load_dwordx4 v[92:95], v6, s[24:27], s46 offen offset:1920 sc1
  s_barrier
  s_waitcnt vmcnt(4)
  v_cvt_pk_bf16_f32 v64, v64, v65
  v_cvt_pk_bf16_f32 v65, v66, v67
  v_cvt_pk_bf16_f32 v66, v68, v69
  v_cvt_pk_bf16_f32 v67, v70, v71
  v_cvt_pk_bf16_f32 v72, v72, v73
  v_cvt_pk_bf16_f32 v73, v74, v75
  v_cvt_pk_bf16_f32 v74, v76, v77
  v_cvt_pk_bf16_f32 v75, v78, v79
  s_mov_b32 exec_hi, 0
  v_cvt_pk_bf16_f32 v12, v96, v97
  v_cvt_pk_bf16_f32 v13, v98, v99
  v_cvt_pk_bf16_f32 v14, v100, v101
  v_cvt_pk_bf16_f32 v15, v102, v103
  s_mov_b64 exec, -1
  v_mfma_f32_32x32x16_bf16 v[24:39], v[64:67], v[168:171], 0
  v_mfma_f32_32x32x16_bf16 v[24:39], v[72:75], v[176:179], v[24:39]
  v_mfma_f32_32x32x16_bf16 v[24:39], v[12:15], v[184:187], v[24:39]
  s_waitcnt vmcnt(0)
  v_cvt_pk_bf16_f32 v80, v80, v81
  v_cvt_pk_bf16_f32 v81, v82, v83
  v_cvt_pk_bf16_f32 v82, v84, v85
  v_cvt_pk_bf16_f32 v83, v86, v87
  v_cvt_pk_bf16_f32 v88, v88, v89
  v_cvt_pk_bf16_f32 v89, v90, v91
  v_cvt_pk_bf16_f32 v90, v92, v93
  v_cvt_pk_bf16_f32 v91, v94, v95
  s_mov_b32 exec_lo, 0
  v_cvt_pk_bf16_f32 v16, v96, v97
  v_cvt_pk_bf16_f32 v17, v98, v99
  v_cvt_pk_bf16_f32 v18, v100, v101
  v_cvt_pk_bf16_f32 v19, v102, v103
  s_mov_b64 exec, -1
  v_mfma_f32_32x32x16_bf16 v[40:55], v[80:83], v[172:175], 0
  v_mfma_f32_32x32x16_bf16 v[40:55], v[88:91], v[180:183], v[40:55]
  v_mfma_f32_32x32x16_bf16 v[40:55], v[16:19], v[184:187], v[40:55]
  v_add_f32 v34, 0x358637bd, v34
  v_rcp_f32 v34, v34
  s_nop 0
  v_pk_mul_f32 v[24:25], v[24:25], v[34:35] op_sel_hi:[1,0]
  v_pk_mul_f32 v[26:27], v[26:27], v[34:35] op_sel_hi:[1,0]
  v_pk_mul_f32 v[28:29], v[28:29], v[34:35] op_sel_hi:[1,0]
  v_pk_mul_f32 v[30:31], v[30:31], v[34:35] op_sel_hi:[1,0]
  v_pk_mul_f32 v[32:33], v[32:33], v[34:35] op_sel_hi:[1,0]
  v_cvt_pk_bf16_f32 v104, v24, v25
  v_cvt_pk_bf16_f32 v105, v26, v27
  v_cvt_pk_bf16_f32 v106, v28, v29
  v_cvt_pk_bf16_f32 v107, v30, v31
  v_cvt_pk_bf16_f32 v108, v32, v33
  buffer_store_dwordx4 v[104:107], v11, s[28:31], s48 offen sc1
  v_add_f32 v50, 0x358637bd, v50
  v_rcp_f32 v50, v50
  s_nop 0
  v_pk_mul_f32 v[40:41], v[40:41], v[50:51] op_sel_hi:[1,0]
  v_pk_mul_f32 v[42:43], v[42:43], v[50:51] op_sel_hi:[1,0]
  v_pk_mul_f32 v[44:45], v[44:45], v[50:51] op_sel_hi:[1,0]
  v_pk_mul_f32 v[46:47], v[46:47], v[50:51] op_sel_hi:[1,0]
  v_pk_mul_f32 v[48:49], v[48:49], v[50:51] op_sel_hi:[1,0]
  v_cvt_pk_bf16_f32 v109, v40, v41
  v_cvt_pk_bf16_f32 v110, v42, v43
  v_cvt_pk_bf16_f32 v111, v44, v45
  v_cvt_pk_bf16_f32 v112, v46, v47
  v_cvt_pk_bf16_f32 v113, v48, v49
  buffer_store_dwordx4 v[108:111], v11, s[28:31], s48 offen offset:512 sc1
  v_permlane32_swap_b32 v112, v114
  v_permlane32_swap_b32 v113, v115
  s_mov_b32 exec_hi, 0
  buffer_store_dwordx4 v[112:115], v10, s[28:31], s48 offen offset:1024 sc1
  s_mov_b32 exec_hi, -1
  buffer_load_dword v63, v62, s[8:11], 0 offen sc1
  s_bfe_u32 s60, s2, 0x10002
  s_lshl_b32 s60, s60, 3
  s_bfe_u32 s40, s2, 0x30003
  s_add_u32 s60, s60, s40
  s_and_b32 s61, s2, 3
  s_lshl_b32 s61, s61, 2
  s_lshr_b32 s40, s2, 6
  s_add_u32 s61, s61, s40
  s_mul_i32 s62, s61, 27
  s_lshr_b32 s62, s62, 1
  s_mul_i32 s40, s62, 20480
  s_add_u32 s12, s20, 8765440
  s_addc_u32 s13, s21, 0
  s_add_u32 s12, s12, s40
  s_addc_u32 s13, s13, 0
  s_mov_b32 s14, 163840
  s_mov_b32 s15, 0x20000
  s_add_u32 s16, s20, 8929280
  s_addc_u32 s17, s21, 0
  s_add_u32 s16, s16, s40
  s_addc_u32 s17, s17, 0
  s_mov_b32 s18, 163840
  s_mov_b32 s19, 0x20000
  s_add_u32 s68, s20, 9093120
  s_addc_u32 s69, s21, 0
  s_add_u32 s68, s68, s40
  s_addc_u32 s69, s69, 0
  s_mov_b32 s70, 40960
  s_mov_b32 s71, 0x20000
  s_waitcnt vmcnt(1)
  s_mov_b64 exec, 1
  v_mov_b32 v8, s93
  v_mov_b32 v9, 0
  buffer_store_dword v8, v9, s[8:11], s49 offen sc0 sc1
  s_mov_b64 exec, -1
  s_sub_u32 s50, s50, 24576
  s_mov_b64 exec, 1
  v_mov_b32 v8, s93
  v_mov_b32 v9, 0
  buffer_store_dword v8, v9, s[8:11], s50 offen sc0 sc1
  s_mov_b64 exec, -1
  s_waitcnt vmcnt(2)
  v_cmp_ne_u32 vcc, s93, v63
  s_mov_b32 s92, 0
  s_nop 3
  s_cbranch_vccz M_f6_ok
M_f6:
  buffer_load_dword v63, v62, s[8:11], 0 offen sc1
  s_add_u32 s92, s92, 1
  s_waitcnt vmcnt(0)
  s_cmp_gt_u32 s92, 400000
  s_cbranch_scc1 M_f6_ok
  v_cmp_ne_u32 vcc, s93, v63
  s_nop 4
  s_cbranch_vccnz M_f6
M_f6_ok:
  s_add_u32 s23, s22, 0
  buffer_load_dwordx4 a[160:163], v3, s[64:67], s23 offen sc1
  s_add_u32 s23, s22, 20480
  buffer_load_dwordx4 a[180:183], v3, s[64:67], s23 offen sc1
  s_add_u32 s23, s22, 40960
  buffer_load_dwordx4 a[200:203], v3, s[64:67], s23 offen sc1
  s_add_u32 s23, s22, 61440
  buffer_load_dwordx4 a[220:223], v3, s[64:67], s23 offen sc1
  s_add_u32 s23, s22, 81920
  buffer_load_dwordx4 a[240:243], v3, s[64:67], s23 offen sc1
  s_add_u32 s23, s22, 1024
  buffer_load_dwordx4 a[164:167], v3, s[64:67], s23 offen sc1
  s_add_u32 s23, s22, 21504
  buffer_load_dwordx4 a[184:187], v3, s[64:67], s23 offen sc1
  s_add_u32 s23, s22, 41984
  buffer_load_dwordx4 a[204:207], v3, s[64:67], s23 offen sc1
  s_add_u32 s23, s22, 62464
  buffer_load_dwordx4 a[224:227], v3, s[64:67], s23 offen sc1
  s_add_u32 s23, s22, 82944
  buffer_load_dwordx4 a[244:247], v3, s[64:67], s23 offen sc1
  s_add_u32 s23, s22, 2048
  buffer_load_dwordx4 a[168:171], v3, s[64:67], s23 offen sc1
  s_add_u32 s23, s22, 22528
  buffer_load_dwordx4 a[188:191], v3, s[64:67], s23 offen sc1
  s_add_u32 s23, s22, 43008
  buffer_load_dwordx4 a[208:211], v3, s[64:67], s23 offen sc1
  s_add_u32 s23, s22, 63488
  buffer_load_dwordx4 a[228:231], v3, s[64:67], s23 offen sc1
  s_add_u32 s23, s22, 83968
  buffer_load_dwordx4 a[248:251], v3, s[64:67], s23 offen sc1
  s_add_u32 s23, s22, 3072
  buffer_load_dwordx4 a[172:175], v3, s[64:67], s23 offen sc1
  s_add_u32 s23, s22, 23552
  buffer_load_dwordx4 a[192:195], v3, s[64:67], s23 offen sc1
  s_add_u32 s23, s22, 44032
  buffer_load_dwordx4 a[212:215], v3, s[64:67], s23 offen sc1
  s_add_u32 s23, s22, 64512
  buffer_load_dwordx4 a[232:235], v3, s[64:67], s23 offen sc1
  s_add_u32 s23, s22, 84992
  buffer_load_dwordx4 a[252:255], v3, s[64:67], s23 offen sc1
  s_add_u32 s23, s22, 4096
  buffer_load_dwordx4 a[176:179], v3, s[64:67], s23 offen sc1
  s_add_u32 s23, s22, 24576
  buffer_load_dwordx4 a[196:199], v3, s[64:67], s23 offen sc1
  s_add_u32 s23, s22, 45056
  buffer_load_dwordx4 a[216:219], v3, s[64:67], s23 offen sc1
  s_add_u32 s23, s22, 65536
  buffer_load_dwordx4 a[236:239], v3, s[64:67], s23 offen sc1
  s_add_u32 s23, s22, 86016
  buffer_load_dwordx4 a[156:159], v3, s[64:67], s23 offen sc1
  s_add_u32 s24, s20, 23265280
  s_addc_u32 s25, s21, 0
  s_mov_b32 s26, 2621440
  s_mov_b32 s27, 0x20000
  s_add_u32 s32, s20, 5242880
  s_addc_u32 s33, s21, 0
  s_mov_b32 s34, 131072
  s_mov_b32 s35, 0x20000
  s_mul_i32 s44, s95, 5
  s_mul_i32 s45, s100, 80
  s_add_u32 s45, s45, s44
  s_lshl_b32 s45, s45, 10
  v_and_b32 v7, 3, v2
  v_lshlrev_b32 v7, 4, v7
  v_bfe_u32 v8, v2, 2, 1
  v_lshl_add_u32 v7, v8, 8, v7
  s_lshl_b32 s46, s100, 9
  s_lshl_b32 s47, s95, 6
  s_add_u32 s46, s46, s47
  s_add_u32 s46, s46, 0
  s_mul_i32 s47, s95, 15360
  v_add_u32 v6, s47, v3
  s_add_u32 s47, s95, 1
  s_and_b32 s47, s47, 3
  s_mul_i32 s47, s47, 15360
  s_add_u32 s47, s47, 10240
  v_add_u32 v10, s47, v3
  s_add_u32 s47, s95, 2
  s_and_b32 s47, s47, 3
  s_mul_i32 s47, s47, 15360
  s_add_u32 s47, s47, 5120
  v_add_u32 v11, s47, v3
  s_add_u32 s47, s95, 3
  s_and_b32 s47, s47, 3
  s_mul_i32 s47, s47, 15360
  s_add_u32 s47, s47, 0
  v_add_u32 v12, s47, v3
  s_bfe_u32 s58, s2, 0x20001
  s_lshl_b32 s58, s58, 3
  s_bfe_u32 s40, s2, 0x30003
  s_add_u32 s58, s58, s40
  s_and_b32 s59, s2, 1
  s_lshl_b32 s59, s59, 2
  s_lshr_b32 s40, s2, 6
  s_add_u32 s59, s59, s40
  v_and_b32 v13, 15, v2
  v_lshrrev_b32 v14, 4, v2
  v_mul_u32_u24 v17, 160, v13
  v_lshl_add_u32 v17, v14, 3, v17
  s_mul_i32 s51, s95, 3072
  s_add_u32 s52, s51, 61440
  v_add_u32 v15, s52, v17
  s_add_u32 s51, s51, 61440
  v_add_u32 v17, s51, v17
  v_mul_u32_u24 v18, 160, v13
  v_lshl_add_u32 v18, v14, 4, v18
  v_add_u32 v18, s51, v18
  v_lshlrev_b32 v19, 4, v13
  v_lshl_add_u32 v19, v4, 9, v19
  v_and_b32 v18, 1, v14
  v_lshl_add_u32 v19, v18, 10, v19
  s_lshl_b32 s48, s100, 1
  s_lshr_b32 s49, s95, 1
  s_add_u32 s48, s48, s49
  s_lshl_b32 s53, s48, 3
  s_add_u32 s53, s53, s101
  s_lshl_b32 s53, s53, 8
  s_mul_i32 s48, s48, 40960
  s_mul_i32 s49, s101, 5120
  s_add_u32 s48, s48, s49
  s_and_b32 s49, s95, 1
  s_lshl_b32 s50, s49, 7
  s_add_u32 s53, s53, s50
  s_lshl_b32 s49, s49, 8
  s_add_u32 s48, s48, s49
  s_add_u32 s49, s48, 4096
  s_lshl_b32 s56, s100, 2
  s_add_u32 s56, s56, s95
  s_lshl_b32 s56, s56, 3
  s_add_u32 s56, s56, s101
  s_lshl_b32 s56, s56, 4
  s_add_u32 s56, s56, 16384
  s_mov_b32 s54, 0xffff0000
  s_lshr_b32 s50, s62, 3
  s_lshl_b32 s50, s50, 2
  v_min_u32 v20, 11, v13
  v_add_u32 v20, s50, v20
  v_min_u32 v20, 107, v20
  v_and_b32 v21, 1, v14
  v_mul_u32_u24 v16, 108, v21
  v_add_u32 v20, v20, v16
  s_mul_i32 s50, s59, 5
  s_lshr_b32 s50, s50, 2
  s_mul_i32 s50, s50, 56
  s_mul_i32 s51, s95, 14
  s_add_u32 s50, s50, s51
  v_min_u32 v16, 13, v13
  v_mul_u32_u24 v21, 56, v21
  v_add3_u32 v16, v16, v21, s50
  v_min_u32 v16, 559, v16
  v_lshrrev_b32 v21, 1, v16
  v_subrev_u32 v22, 304, v16
  v_cmp_le_u32 vcc, 512, v16
  s_nop 1
  v_cndmask_b32 v16, v21, v22, vcc
  v_cmp_le_u32 vcc, 32, v2
  s_nop 1
  v_cndmask_b32 v20, v20, v16, vcc
  v_lshlrev_b32 v20, 4, v20
  s_mov_b32 s57, 57344
  ds_read_b64 v[112:113], v15 offset:0
  ds_read_b64 v[114:115], v15 offset:32
  ds_read_b64 v[116:117], v15 offset:64
  ds_read_b64 v[118:119], v15 offset:96
  ds_read_b64 v[120:121], v15 offset:128
  s_waitcnt lgkmcnt(0)
  v_lshlrev_b32 v128, 16, v112
  v_and_b32 v129, s54, v112
  v_lshlrev_b32 v130, 16, v113
  v_and_b32 v131, s54, v113
  v_lshlrev_b32 v132, 16, v114
  v_and_b32 v133, s54, v114
  v_lshlrev_b32 v134, 16, v115
  v_and_b32 v135, s54, v115
  v_lshlrev_b32 v136, 16, v116
  v_and_b32 v137, s54, v116
  v_lshlrev_b32 v138, 16, v117
  v_and_b32 v139, s54, v117
  v_lshlrev_b32 v140, 16, v118
  v_and_b32 v141, s54, v118
  v_lshlrev_b32 v142, 16, v119
  v_and_b32 v143, s54, v119
  v_lshlrev_b32 v144, 16, v120
  v_and_b32 v145, s54, v120
  v_lshlrev_b32 v146, 16, v121
  v_and_b32 v147, s54, v121
  s_mov_b32 s92, 0
M_poll2b:
  buffer_load_dword v9, v7, s[8:11], s46 offen sc1
  s_add_u32 s92, s92, 1
  s_cmp_gt_u32 s92, 400000
  s_cbranch_scc1 M_poll2b_go
  s_waitcnt vmcnt(0)
  v_cmp_ne_u32 vcc, s93, v9
  s_nop 4
  s_cbranch_vccnz M_poll2b
M_poll2b_go:
  s_waitcnt vmcnt(0)
  s_add_u32 s55, s95, 1
  s_and_b32 s55, s55, 3
  s_mul_i32 s55, s55, 20480
  s_add_u32 s55, s55, s45
  buffer_load_dwordx4 a[0:3], v3, s[28:31], s55 offen offset:0 sc1
  buffer_load_dwordx4 a[4:7], v3, s[28:31], s55 offen offset:1024 sc1
  buffer_load_dwordx4 a[8:11], v3, s[28:31], s55 offen offset:2048 sc1
  buffer_load_dwordx4 a[12:15], v3, s[28:31], s55 offen offset:3072 sc1
  s_add_u32 s55, s55, 4096
  buffer_load_dwordx4 a[16:19], v3, s[28:31], s55 offen offset:0 sc1
  s_add_u32 s55, s95, 2
  s_and_b32 s55, s55, 3
  s_mul_i32 s55, s55, 20480
  s_add_u32 s55, s55, s45
  buffer_load_dwordx4 a[20:23], v3, s[28:31], s55 offen offset:0 sc1
  buffer_load_dwordx4 a[24:27], v3, s[28:31], s55 offen offset:1024 sc1
  buffer_load_dwordx4 a[28:31], v3, s[28:31], s55 offen offset:2048 sc1
  buffer_load_dwordx4 a[32:35], v3, s[28:31], s55 offen offset:3072 sc1
  buffer_load_dword v21, v20, s[8:11], s57 offen sc1
  s_add_u32 s55, s55, 4096
  buffer_load_dwordx4 a[36:39], v3, s[28:31], s55 offen offset:0 sc1
  s_add_u32 s55, s95, 3
  s_and_b32 s55, s55, 3
  s_mul_i32 s55, s55, 20480
  s_add_u32 s55, s55, s45
  buffer_load_dwordx4 a[40:43], v3, s[28:31], s55 offen offset:0 sc1
  s_waitcnt vmcnt(11)
  v_mfma_f32_16x16x32_bf16 v[72:75], a[160:163], a[0:3], 0
  v_mfma_f32_16x16x32_bf16 v[76:79], a[180:183], a[0:3], 0
  buffer_load_dwordx4 a[44:47], v3, s[28:31], s55 offen offset:1024 sc1
  v_mfma_f32_16x16x32_bf16 v[80:83], a[200:203], a[0:3], 0
  v_mfma_f32_16x16x32_bf16 v[84:87], a[220:223], a[0:3], 0
  buffer_load_dwordx4 a[48:51], v3, s[28:31], s55 offen offset:2048 sc1
  v_mfma_f32_16x16x32_bf16 v[88:91], a[240:243], a[0:3], 0
  s_waitcnt vmcnt(12)
  v_mfma_f32_16x16x32_bf16 v[72:75], a[164:167], a[4:7], v[72:75]
  v_mfma_f32_16x16x32_bf16 v[76:79], a[184:187], a[4:7], v[76:79]
  buffer_load_dwordx4 a[52:55], v3, s[28:31], s55 offen offset:3072 sc1
  v_mfma_f32_16x16x32_bf16 v[80:83], a[204:207], a[4:7], v[80:83]
  v_mfma_f32_16x16x32_bf16 v[84:87], a[224:227], a[4:7], v[84:87]
  s_add_u32 s55, s55, 4096
  buffer_load_dwordx4 a[56:59], v3, s[28:31], s55 offen offset:0 sc1
  v_mfma_f32_16x16x32_bf16 v[88:91], a[244:247], a[4:7], v[88:91]
  s_waitcnt vmcnt(13)
  v_mfma_f32_16x16x32_bf16 v[72:75], a[168:171], a[8:11], v[72:75]
  v_mfma_f32_16x16x32_bf16 v[76:79], a[188:191], a[8:11], v[76:79]
  s_add_u32 s55, s95, 0
  s_and_b32 s55, s55, 3
  s_mul_i32 s55, s55, 20480
  s_add_u32 s55, s55, s45
  buffer_load_dwordx4 a[60:63], v3, s[28:31], s55 offen offset:0 sc1
  v_mfma_f32_16x16x32_bf16 v[80:83], a[208:211], a[8:11], v[80:83]
  v_mfma_f32_16x16x32_bf16 v[84:87], a[228:231], a[8:11], v[84:87]
  buffer_load_dwordx4 a[64:67], v3, s[28:31], s55 offen offset:1024 sc1
  v_mfma_f32_16x16x32_bf16 v[88:91], a[248:251], a[8:11], v[88:91]
  s_waitcnt vmcnt(14)
  v_mfma_f32_16x16x32_bf16 v[72:75], a[172:175], a[12:15], v[72:75]
  v_mfma_f32_16x16x32_bf16 v[76:79], a[192:195], a[12:15], v[76:79]
  buffer_load_dwordx4 a[68:71], v3, s[28:31], s55 offen offset:2048 sc1
  v_mfma_f32_16x16x32_bf16 v[80:83], a[212:215], a[12:15], v[80:83]
  v_mfma_f32_16x16x32_bf16 v[84:87], a[232:235], a[12:15], v[84:87]
  buffer_load_dwordx4 a[72:75], v3, s[28:31], s55 offen offset:3072 sc1
  v_mfma_f32_16x16x32_bf16 v[88:91], a[252:255], a[12:15], v[88:91]
  s_waitcnt vmcnt(15)
  v_mfma_f32_16x16x32_bf16 v[72:75], a[176:179], a[16:19], v[72:75]
  v_mfma_f32_16x16x32_bf16 v[76:79], a[196:199], a[16:19], v[76:79]
  s_add_u32 s55, s55, 4096
  buffer_load_dwordx4 a[76:79], v3, s[28:31], s55 offen offset:0 sc1
  v_mfma_f32_16x16x32_bf16 v[80:83], a[216:219], a[16:19], v[80:83]
  v_mfma_f32_16x16x32_bf16 v[84:87], a[236:239], a[16:19], v[84:87]
  v_mfma_f32_16x16x32_bf16 v[88:91], a[156:159], a[16:19], v[88:91]
  s_waitcnt vmcnt(15)
  v_mfma_f32_16x16x32_bf16 v[92:95], a[160:163], a[20:23], 0
  v_mfma_f32_16x16x32_bf16 v[96:99], a[180:183], a[20:23], 0
  v_mfma_f32_16x16x32_bf16 v[100:103], a[200:203], a[20:23], 0
  v_mfma_f32_16x16x32_bf16 v[104:107], a[220:223], a[20:23], 0
  v_mfma_f32_16x16x32_bf16 v[108:111], a[240:243], a[20:23], 0
  s_waitcnt vmcnt(14)
  v_mfma_f32_16x16x32_bf16 v[92:95], a[164:167], a[24:27], v[92:95]
  ds_write_b128 v6, v[72:75] offset:0
  v_mfma_f32_16x16x32_bf16 v[96:99], a[184:187], a[24:27], v[96:99]
  v_mfma_f32_16x16x32_bf16 v[100:103], a[204:207], a[24:27], v[100:103]
  ds_write_b128 v6, v[76:79] offset:1024
  v_mfma_f32_16x16x32_bf16 v[104:107], a[224:227], a[24:27], v[104:107]
  v_mfma_f32_16x16x32_bf16 v[108:111], a[244:247], a[24:27], v[108:111]
  ds_write_b128 v6, v[80:83] offset:2048
  s_waitcnt vmcnt(13)
  v_mfma_f32_16x16x32_bf16 v[92:95], a[168:171], a[28:31], v[92:95]
  ds_write_b128 v6, v[84:87] offset:3072
  v_mfma_f32_16x16x32_bf16 v[96:99], a[188:191], a[28:31], v[96:99]
  v_mfma_f32_16x16x32_bf16 v[100:103], a[208:211], a[28:31], v[100:103]
  ds_write_b128 v6, v[88:91] offset:4096
  v_mfma_f32_16x16x32_bf16 v[104:107], a[228:231], a[28:31], v[104:107]
  v_mfma_f32_16x16x32_bf16 v[108:111], a[248:251], a[28:31], v[108:111]
  s_waitcnt vmcnt(12)
  v_mfma_f32_16x16x32_bf16 v[92:95], a[172:175], a[32:35], v[92:95]
  v_mfma_f32_16x16x32_bf16 v[96:99], a[192:195], a[32:35], v[96:99]
  v_mfma_f32_16x16x32_bf16 v[100:103], a[212:215], a[32:35], v[100:103]
  v_mfma_f32_16x16x32_bf16 v[104:107], a[232:235], a[32:35], v[104:107]
  v_mfma_f32_16x16x32_bf16 v[108:111], a[252:255], a[32:35], v[108:111]
  s_waitcnt vmcnt(10)
  v_cmp_ne_u32 vcc, s93, v21
  s_mov_b32 s92, 0
  s_nop 3
  s_cbranch_vccz M_f5_ok
M_f5:
  buffer_load_dword v21, v20, s[8:11], s57 offen sc1
  s_add_u32 s92, s92, 1
  s_waitcnt vmcnt(0)
  s_cmp_gt_u32 s92, 400000
  s_cbranch_scc1 M_f5_ok
  v_cmp_ne_u32 vcc, s93, v21
  s_nop 4
  s_cbranch_vccnz M_f5
M_f5_ok:
  v_mfma_f32_16x16x32_bf16 v[92:95], a[176:179], a[36:39], v[92:95]
  v_mfma_f32_16x16x32_bf16 v[96:99], a[196:199], a[36:39], v[96:99]
  s_add_u32 m0, s3, 81920
  s_nop 0
  buffer_load_dwordx4 v3, s[12:15], m0 offen offset:0 sc1 lds
  v_mfma_f32_16x16x32_bf16 v[100:103], a[216:219], a[36:39], v[100:103]
  v_mfma_f32_16x16x32_bf16 v[104:107], a[236:239], a[36:39], v[104:107]
  buffer_load_dwordx4 v3, s[12:15], m0 offen offset:1024 sc1 lds
  v_mfma_f32_16x16x32_bf16 v[108:111], a[156:159], a[36:39], v[108:111]
  s_waitcnt vmcnt(11)
  v_mfma_f32_16x16x32_bf16 v[72:75], a[160:163], a[40:43], 0
  v_mfma_f32_16x16x32_bf16 v[76:79], a[180:183], a[40:43], 0
  buffer_load_dwordx4 v3, s[12:15], m0 offen offset:2048 sc1 lds
  v_mfma_f32_16x16x32_bf16 v[80:83], a[200:203], a[40:43], 0
  v_mfma_f32_16x16x32_bf16 v[84:87], a[220:223], a[40:43], 0
  buffer_load_dwordx4 v3, s[12:15], m0 offen offset:3072 sc1 lds
  v_mfma_f32_16x16x32_bf16 v[88:91], a[240:243], a[40:43], 0
  s_waitcnt vmcnt(12)
  v_mfma_f32_16x16x32_bf16 v[72:75], a[164:167], a[44:47], v[72:75]
  ds_write_b128 v6, v[92:95] offset:5120
  v_mfma_f32_16x16x32_bf16 v[76:79], a[184:187], a[44:47], v[76:79]
  s_add_u32 m0, s3, 86016
  s_nop 0
  buffer_load_dwordx4 v3, s[12:15], m0 offen offset:0 sc1 lds
  v_mfma_f32_16x16x32_bf16 v[80:83], a[204:207], a[44:47], v[80:83]
  ds_write_b128 v6, v[96:99] offset:6144
  v_mfma_f32_16x16x32_bf16 v[84:87], a[224:227], a[44:47], v[84:87]
  buffer_load_dwordx4 v3, s[12:15], m0 offen offset:1024 sc1 lds
  v_mfma_f32_16x16x32_bf16 v[88:91], a[244:247], a[44:47], v[88:91]
  ds_write_b128 v6, v[100:103] offset:7168
  s_waitcnt vmcnt(13)
  v_mfma_f32_16x16x32_bf16 v[72:75], a[168:171], a[48:51], v[72:75]
  ds_write_b128 v6, v[104:107] offset:8192
  v_mfma_f32_16x16x32_bf16 v[76:79], a[188:191], a[48:51], v[76:79]
  buffer_load_dwordx4 v3, s[12:15], m0 offen offset:2048 sc1 lds
  v_mfma_f32_16x16x32_bf16 v[80:83], a[208:211], a[48:51], v[80:83]
  ds_write_b128 v6, v[108:111] offset:9216
  v_mfma_f32_16x16x32_bf16 v[84:87], a[228:231], a[48:51], v[84:87]
  buffer_load_dwordx4 v3, s[12:15], m0 offen offset:3072 sc1 lds
  v_mfma_f32_16x16x32_bf16 v[88:91], a[248:251], a[48:51], v[88:91]
  s_waitcnt vmcnt(14)
  v_mfma_f32_16x16x32_bf16 v[72:75], a[172:175], a[52:55], v[72:75]
  v_mfma_f32_16x16x32_bf16 v[76:79], a[192:195], a[52:55], v[76:79]
  s_add_u32 m0, s3, 90112
  s_nop 0
  buffer_load_dwordx4 v3, s[12:15], m0 offen offset:0 sc1 lds
  v_mfma_f32_16x16x32_bf16 v[80:83], a[212:215], a[52:55], v[80:83]
  v_mfma_f32_16x16x32_bf16 v[84:87], a[232:235], a[52:55], v[84:87]
  buffer_load_dwordx4 v3, s[12:15], m0 offen offset:1024 sc1 lds
  v_mfma_f32_16x16x32_bf16 v[88:91], a[252:255], a[52:55], v[88:91]
  s_waitcnt vmcnt(15)
  v_mfma_f32_16x16x32_bf16 v[72:75], a[176:179], a[56:59], v[72:75]
  v_mfma_f32_16x16x32_bf16 v[76:79], a[196:199], a[56:59], v[76:79]
  s_add_u32 m0, s3, 122880
  s_nop 0
  buffer_load_dwordx4 v3, s[12:15], m0 offen offset:0 sc1 lds
  v_mfma_f32_16x16x32_bf16 v[80:83], a[216:219], a[56:59], v[80:83]
  v_mfma_f32_16x16x32_bf16 v[84:87], a[236:239], a[56:59], v[84:87]
  buffer_load_dwordx4 v3, s[12:15], m0 offen offset:1024 sc1 lds
  v_mfma_f32_16x16x32_bf16 v[88:91], a[156:159], a[56:59], v[88:91]
  s_waitcnt vmcnt(16)
  s_waitcnt lgkmcnt(0)
  s_barrier
  ds_read_b128 v[24:27], v12 offset:0
  ds_read_b128 v[28:31], v12 offset:1024
  ds_read_b128 v[32:35], v12 offset:2048
  ds_read_b128 v[36:39], v12 offset:3072
  ds_read_b128 v[40:43], v12 offset:4096
  ds_read_b128 v[44:47], v11 offset:0
  ds_read_b128 v[48:51], v11 offset:1024
  ds_read_b128 v[52:55], v11 offset:2048
  ds_read_b128 v[56:59], v11 offset:3072
  ds_read_b128 v[60:63], v11 offset:4096
  v_mfma_f32_16x16x32_bf16 v[128:131], a[160:163], a[60:63], v[128:131]
  v_mfma_f32_16x16x32_bf16 v[132:135], a[180:183], a[60:63], v[132:135]
  buffer_load_dwordx4 v3, s[12:15], m0 offen offset:2048 sc1 lds
  v_mfma_f32_16x16x32_bf16 v[136:139], a[200:203], a[60:63], v[136:139]
  v_mfma_f32_16x16x32_bf16 v[140:143], a[220:223], a[60:63], v[140:143]
  buffer_load_dwordx4 v3, s[12:15], m0 offen offset:3072 sc1 lds
  v_mfma_f32_16x16x32_bf16 v[144:147], a[240:243], a[60:63], v[144:147]
  s_waitcnt vmcnt(17)
  v_mfma_f32_16x16x32_bf16 v[128:131], a[164:167], a[64:67], v[128:131]
  ds_write_b128 v6, v[72:75] offset:10240
  v_mfma_f32_16x16x32_bf16 v[132:135], a[184:187], a[64:67], v[132:135]
  s_add_u32 m0, s3, 126976
  s_nop 0
  buffer_load_dwordx4 v3, s[12:15], m0 offen offset:0 sc1 lds
  v_mfma_f32_16x16x32_bf16 v[136:139], a[204:207], a[64:67], v[136:139]
  ds_write_b128 v6, v[76:79] offset:11264
  v_mfma_f32_16x16x32_bf16 v[140:143], a[224:227], a[64:67], v[140:143]
  buffer_load_dwordx4 v3, s[12:15], m0 offen offset:1024 sc1 lds
  v_mfma_f32_16x16x32_bf16 v[144:147], a[244:247], a[64:67], v[144:147]
  ds_write_b128 v6, v[80:83] offset:12288
  s_waitcnt vmcnt(18)
  s_waitcnt lgkmcnt(3)
  v_mfma_f32_16x16x32_bf16 v[128:131], a[168:171], a[68:71], v[128:131]
  ds_write_b128 v6, v[84:87] offset:13312
  v_mfma_f32_16x16x32_bf16 v[132:135], a[188:191], a[68:71], v[132:135]
  buffer_load_dwordx4 v3, s[12:15], m0 offen offset:2048 sc1 lds
  v_mfma_f32_16x16x32_bf16 v[136:139], a[208:211], a[68:71], v[136:139]
  ds_write_b128 v6, v[88:91] offset:14336
  v_mfma_f32_16x16x32_bf16 v[140:143], a[228:231], a[68:71], v[140:143]
  buffer_load_dwordx4 v3, s[12:15], m0 offen offset:3072 sc1 lds
  v_mfma_f32_16x16x32_bf16 v[144:147], a[248:251], a[68:71], v[144:147]
  v_add_f32 v24, v24, v44
  v_add_f32 v25, v25, v45
  s_waitcnt vmcnt(19)
  v_mfma_f32_16x16x32_bf16 v[128:131], a[172:175], a[72:75], v[128:131]
  v_add_f32 v26, v26, v46
  v_add_f32 v27, v27, v47
  v_mfma_f32_16x16x32_bf16 v[132:135], a[192:195], a[72:75], v[132:135]
  s_add_u32 m0, s3, 131072
  s_nop 0
  buffer_load_dwordx4 v3, s[12:15], m0 offen offset:0 sc1 lds
  v_mfma_f32_16x16x32_bf16 v[136:139], a[212:215], a[72:75], v[136:139]
  v_add_f32 v28, v28, v48
  v_add_f32 v29, v29, v49
  v_mfma_f32_16x16x32_bf16 v[140:143], a[232:235], a[72:75], v[140:143]
  buffer_load_dwordx4 v3, s[12:15], m0 offen offset:1024 sc1 lds
  v_mfma_f32_16x16x32_bf16 v[144:147], a[252:255], a[72:75], v[144:147]
  v_add_f32 v30, v30, v50
  v_add_f32 v31, v31, v51
  s_waitcnt vmcnt(20)
  v_mfma_f32_16x16x32_bf16 v[128:131], a[176:179], a[76:79], v[128:131]
  v_add_f32 v32, v32, v52
  v_add_f32 v33, v33, v53
  v_mfma_f32_16x16x32_bf16 v[132:135], a[196:199], a[76:79], v[132:135]
  v_mfma_f32_16x16x32_bf16 v[136:139], a[216:219], a[76:79], v[136:139]
  v_add_f32 v34, v34, v54
  v_add_f32 v35, v35, v55
  v_mfma_f32_16x16x32_bf16 v[140:143], a[236:239], a[76:79], v[140:143]
  v_mfma_f32_16x16x32_bf16 v[144:147], a[156:159], a[76:79], v[144:147]
  v_add_f32 v36, v36, v56
  v_add_f32 v37, v37, v57
  s_waitcnt lgkmcnt(0)
  s_barrier
  ds_read_b128 v[72:75], v10 offset:0
  ds_read_b128 v[76:79], v10 offset:1024
  ds_read_b128 v[80:83], v10 offset:2048
  ds_read_b128 v[84:87], v10 offset:3072
  ds_read_b128 v[88:91], v10 offset:4096
  v_add_f32 v38, v38, v58
  v_add_f32 v39, v39, v59
  v_add_f32 v40, v40, v60
  v_add_f32 v41, v41, v61
  v_add_f32 v42, v42, v62
  v_add_f32 v43, v43, v63
  v_mov_b32 v14, 0x3f803f80
  v_mov_b32 v112, 0
  v_mov_b32 v113, 0
  v_pk_add_f32 v[128:129], v[128:129], v[24:25]
  v_pk_add_f32 v[130:131], v[130:131], v[26:27]
  v_pk_add_f32 v[132:133], v[132:133], v[28:29]
  v_pk_add_f32 v[134:135], v[134:135], v[30:31]
  v_pk_add_f32 v[136:137], v[136:137], v[32:33]
  v_pk_add_f32 v[138:139], v[138:139], v[34:35]
  v_pk_add_f32 v[140:141], v[140:141], v[36:37]
  v_pk_add_f32 v[142:143], v[142:143], v[38:39]
  v_pk_add_f32 v[144:145], v[144:145], v[40:41]
  v_pk_add_f32 v[146:147], v[146:147], v[42:43]
  s_waitcnt lgkmcnt(0)
  v_pk_add_f32 v[128:129], v[128:129], v[72:73]
  v_pk_add_f32 v[130:131], v[130:131], v[74:75]
  v_pk_add_f32 v[132:133], v[132:133], v[76:77]
  v_pk_add_f32 v[134:135], v[134:135], v[78:79]
  v_pk_add_f32 v[136:137], v[136:137], v[80:81]
  v_pk_add_f32 v[138:139], v[138:139], v[82:83]
  v_pk_add_f32 v[140:141], v[140:141], v[84:85]
  v_pk_add_f32 v[142:143], v[142:143], v[86:87]
  v_pk_add_f32 v[144:145], v[144:145], v[88:89]
  v_pk_add_f32 v[146:147], v[146:147], v[90:91]
  v_cvt_pk_bf16_f32 v24, v128, v129
  v_cvt_pk_bf16_f32 v25, v130, v131
  v_cvt_pk_bf16_f32 v26, v132, v133
  v_cvt_pk_bf16_f32 v27, v134, v135
  v_cvt_pk_bf16_f32 v28, v136, v137
  v_cvt_pk_bf16_f32 v29, v138, v139
  v_cvt_pk_bf16_f32 v30, v140, v141
  v_cvt_pk_bf16_f32 v31, v142, v143
  v_cvt_pk_bf16_f32 v32, v144, v145
  v_cvt_pk_bf16_f32 v33, v146, v147
  v_dot2c_f32_bf16 v112, v32, v14
  v_dot2c_f32_bf16 v113, v32, v32
  v_dot2c_f32_bf16 v112, v33, v14
  v_dot2c_f32_bf16 v113, v33, v33
  v_permlane16_swap_b32 v24, v26
  v_permlane16_swap_b32 v25, v27
  buffer_store_dwordx4 v[24:27], v19, s[24:27], s48 offen offset:0 sc1
  v_permlane16_swap_b32 v28, v30
  v_permlane16_swap_b32 v29, v31
  buffer_store_dwordx4 v[28:31], v19, s[24:27], s48 offen offset:2048 sc1
  v_permlane16_swap_b32 v32, v34
  v_permlane16_swap_b32 v33, v35
  s_mov_b32 exec_lo, 0xffff
  s_mov_b32 exec_hi, 0xffff
  buffer_store_dwordx4 v[32:35], v19, s[24:27], s49 offen offset:0 sc1
  s_mov_b64 exec, -1
  v_dot2c_f32_bf16 v112, v24, v14
  v_dot2c_f32_bf16 v113, v24, v24
  v_dot2c_f32_bf16 v112, v25, v14
  v_dot2c_f32_bf16 v113, v25, v25
  v_dot2c_f32_bf16 v112, v26, v14
  v_dot2c_f32_bf16 v113, v26, v26
  v_dot2c_f32_bf16 v112, v27, v14
  v_dot2c_f32_bf16 v113, v27, v27
  v_dot2c_f32_bf16 v112, v28, v14
  v_dot2c_f32_bf16 v113, v28, v28
  v_dot2c_f32_bf16 v112, v29, v14
  v_dot2c_f32_bf16 v113, v29, v29
  v_dot2c_f32_bf16 v112, v30, v14
  v_dot2c_f32_bf16 v113, v30, v30
  v_dot2c_f32_bf16 v112, v31, v14
  v_dot2c_f32_bf16 v113, v31, v31
  v_lshlrev_b32 v13, 3, v13
  s_nop 1
  v_mov_b32 v114, v112
  v_mov_b32 v115, v113
  s_nop 0
  v_permlane32_swap_b32 v112, v114
  v_permlane32_swap_b32 v113, v115
  v_pk_add_f32 v[112:113], v[112:113], v[114:115]
  v_mov_b32 v114, v112
  v_mov_b32 v115, v113
  s_nop 0
  v_permlane16_swap_b32 v112, v114
  v_permlane16_swap_b32 v113, v115
  v_pk_add_f32 v[112:113], v[112:113], v[114:115]
  s_mov_b64 exec, 0xffff
  buffer_store_dwordx2 v[112:113], v13, s[32:35], s53 offen sc1
  s_mov_b64 exec, -1
  s_add_u32 s28, s20, 5242880
  s_addc_u32 s29, s21, 0
  s_mov_b32 s30, 131072
  s_mov_b32 s31, 0x20000
  s_waitcnt vmcnt(0)
  s_mov_b64 exec, 1
  v_mov_b32 v8, s93
  v_mov_b32 v9, 0
  buffer_store_dword v8, v9, s[8:11], s56 offen sc0 sc1
  s_mov_b64 exec, -1
  s_barrier
  s_add_u32 m0, s3, 0
  s_nop 0
  buffer_load_dwordx4 v3, s[16:19], m0 offen offset:0 sc1 lds
  buffer_load_dwordx4 v3, s[16:19], m0 offen offset:1024 sc1 lds
  buffer_load_dwordx4 v3, s[16:19], m0 offen offset:2048 sc1 lds
  buffer_load_dwordx4 v3, s[16:19], m0 offen offset:3072 sc1 lds
  s_add_u32 m0, s3, 4096
  s_nop 0
  buffer_load_dwordx4 v3, s[16:19], m0 offen offset:0 sc1 lds
  buffer_load_dwordx4 v3, s[16:19], m0 offen offset:1024 sc1 lds
  buffer_load_dwordx4 v3, s[16:19], m0 offen offset:2048 sc1 lds
  buffer_load_dwordx4 v3, s[16:19], m0 offen offset:3072 sc1 lds
  s_add_u32 m0, s3, 8192
  s_nop 0
  buffer_load_dwordx4 v3, s[16:19], m0 offen offset:0 sc1 lds
  buffer_load_dwordx4 v3, s[16:19], m0 offen offset:1024 sc1 lds
  s_bfe_u32 s100, s2, 0x20001
  s_lshl_b32 s100, s100, 3
  s_bfe_u32 s40, s2, 0x30003
  s_add_u32 s100, s100, s40
  s_and_b32 s101, s2, 1
  s_lshl_b32 s101, s101, 2
  s_lshr_b32 s40, s2, 6
  s_add_u32 s101, s101, s40
  s_mul_i32 s96, s101, 0
  s_add_u32 s96, s96, s95
  s_and_b32 s96, s96, 3
  s_lshl_b32 s44, s60, 2
  s_add_u32 s44, s44, s95
  s_mul_i32 s45, s44, 40960
  v_bfe_u32 v7, v2, 2, 1
  v_bfe_u32 v8, v2, 4, 1
  v_xor_b32 v9, v8, v4
  v_lshlrev_b32 v9, 7, v9
  v_lshl_add_u32 v9, v8, 8, v9
  v_bfe_u32 v8, v2, 3, 1
  v_lshl_add_u32 v9, v8, 6, v9
  v_and_b32 v8, 3, v2
  v_lshl_add_u32 v9, v8, 4, v9
  v_lshl_add_u32 v8, v7, 9, v9
  v_mul_u32_u24 v7, 20480, v7
  v_add_u32 v10, v7, v9
  v_add_u32 v11, 40960, v10
  v_add_u32 v12, 81920, v10
  v_add_u32 v13, 122880, v10
  s_add_u32 s12, s20, 5505024
  s_addc_u32 s13, s21, 0
  s_mov_b32 s14, 110592
  s_mov_b32 s15, 0x20000
  s_lshl_b32 s46, s62, 9
  s_add_u32 s47, s46, 4096
  v_mov_b32 v0, v8
  buffer_load_dwordx4 a[160:163], v0, s[12:15], s46 offen offset:0 sc1
  buffer_load_dwordx4 a[164:167], v0, s[12:15], s46 offen offset:1024 sc1
  buffer_load_dwordx4 a[168:171], v0, s[12:15], s46 offen offset:2048 sc1
  s_add_u32 s36, s20, 13303808
  s_addc_u32 s37, s21, 0
  s_mov_b32 s38, 7340032
  s_mov_b32 s39, 0x20000
  s_add_u32 s32, s20, 5636096
  s_addc_u32 s33, s21, 0
  s_mov_b32 s34, 32768
  s_mov_b32 s35, 0x20000
  v_lshlrev_b32 v6, 3, v5
  v_lshl_add_u32 v6, v4, 10, v6
  s_lshl_b32 s48, s44, 11
  v_lshrrev_b32 v20, 4, v5
  v_mul_u32_u24 v20, 57344, v20
  v_and_b32 v21, 15, v2
  v_lshlrev_b32 v7, 4, v21
  v_add_u32 v20, v7, v20
  v_lshl_add_u32 v20, v4, 8, v20
  s_mul_i32 s50, s44, 114688
  s_lshr_b32 s51, s61, 2
  s_mul_i32 s51, s51, 14336
  s_add_u32 s50, s50, s51
  s_and_b32 s51, s61, 3
  s_lshl_b32 s51, s51, 9
  s_add_u32 s50, s50, s51
  s_lshr_b32 s51, s44, 1
  s_lshl_b32 s51, s51, 2
  s_lshr_b32 s52, s61, 2
  s_add_u32 s51, s51, s52
  s_lshl_b32 s51, s51, 7
  s_and_b32 s52, s44, 1
  s_lshl_b32 s52, s52, 4
  s_add_u32 s51, s51, s52
  s_and_b32 s52, s61, 3
  s_lshl_b32 s52, s52, 2
  s_add_u32 s51, s51, s52
  v_mov_b32 v8, 0x1000000
  v_writelane_b32 v8, s51, 0
  s_mov_b32 s58, 65536
  s_mov_b32 s59, 32768
  s_lshl_b32 s51, s44, 8
  s_add_u32 s51, s51, 16384
  s_lshr_b32 s52, s61, 2
  s_lshl_b32 s52, s52, 13
  s_lshl_b32 s53, s44, 7
  s_add_u32 s52, s52, s53
  s_and_b32 s53, s61, 3
  s_cmp_eq_u32 s53, 1
  s_cselect_b32 s52, s52, 0x1000000
  s_add_u32 s64, s20, 6553600
  s_addc_u32 s65, s21, 0
  s_mov_b32 s66, 2293760
  s_mov_b32 s67, 0x20000
  s_mul_i32 s40, s95, 14
  s_mul_i32 s22, s101, 280
  s_add_u32 s22, s22, s40
  s_lshl_b32 s22, s22, 10
  s_add_u32 s23, s22, 0
  buffer_load_dwordx4 a[172:175], v3, s[64:67], s23 offen sc1
  s_add_u32 s23, s22, 57344
  buffer_load_dwordx4 a[176:179], v3, s[64:67], s23 offen sc1
  s_add_u32 s23, s22, 114688
  buffer_load_dwordx4 a[180:183], v3, s[64:67], s23 offen sc1
  s_add_u32 s23, s22, 172032
  buffer_load_dwordx4 a[184:187], v3, s[64:67], s23 offen sc1
  s_add_u32 s23, s22, 229376
  buffer_load_dwordx4 a[188:191], v3, s[64:67], s23 offen sc1
  s_add_u32 s23, s22, 1024
  buffer_load_dwordx4 a[192:195], v3, s[64:67], s23 offen sc1
  s_add_u32 s23, s22, 58368
  buffer_load_dwordx4 a[196:199], v3, s[64:67], s23 offen sc1
  s_add_u32 s23, s22, 115712
  buffer_load_dwordx4 a[200:203], v3, s[64:67], s23 offen sc1
  s_add_u32 s23, s22, 173056
  buffer_load_dwordx4 a[204:207], v3, s[64:67], s23 offen sc1
  s_add_u32 s23, s22, 230400
  buffer_load_dwordx4 a[208:211], v3, s[64:67], s23 offen sc1
  s_add_u32 s23, s22, 2048
  buffer_load_dwordx4 a[212:215], v3, s[64:67], s23 offen sc1
  s_add_u32 s23, s22, 59392
  buffer_load_dwordx4 a[216:219], v3, s[64:67], s23 offen sc1
  s_mov_b32 s92, 0
M_poll3:
  buffer_load_dword v9, v7, s[8:11], s51 offen sc1
  s_add_u32 s92, s92, 1
  s_cmp_gt_u32 s92, 400000
  s_cbranch_scc1 M_poll3_go
  s_waitcnt vmcnt(0)
  v_cmp_ne_u32 vcc, s93, v9
  s_nop 4
  s_cbranch_vccnz M_poll3
M_poll3_go:
  s_waitcnt vmcnt(0)
  v_mov_b32 v1, s93
  buffer_load_dwordx4 a[0:3], v3, s[24:27], s45 offen offset:0 sc1
  buffer_load_dwordx4 a[4:7], v3, s[24:27], s45 offen offset:1024 sc1
  buffer_load_dwordx4 a[8:11], v3, s[24:27], s45 offen offset:2048 sc1
  buffer_load_dwordx4 a[12:15], v3, s[24:27], s45 offen offset:3072 sc1
  s_add_u32 s45, s45, 4096
  buffer_load_dwordx4 a[16:19], v3, s[24:27], s45 offen offset:0 sc1
  buffer_load_dwordx4 a[20:23], v3, s[24:27], s45 offen offset:1024 sc1
  buffer_load_dwordx4 a[24:27], v3, s[24:27], s45 offen offset:2048 sc1
  buffer_load_dwordx4 a[28:31], v3, s[24:27], s45 offen offset:3072 sc1
  s_add_u32 s45, s45, 4096
  buffer_load_dwordx4 a[32:35], v3, s[24:27], s45 offen offset:0 sc1
  buffer_load_dwordx4 a[36:39], v3, s[24:27], s45 offen offset:1024 sc1
  buffer_load_dwordx4 a[40:43], v3, s[24:27], s45 offen offset:2048 sc1
  buffer_load_dwordx4 a[44:47], v3, s[24:27], s45 offen offset:3072 sc1
  s_add_u32 s45, s45, 4096
  v_and_b32 v7, 7, v2
  s_lshl_b32 s40, s100, 9
  s_lshl_b32 s41, s95, 7
  s_add_u32 s63, s40, s41
  v_lshl_add_u32 v7, v7, 2, s63
  s_mul_i32 s40, s95, 14
  s_mul_i32 s57, s100, 224
  s_add_u32 s57, s57, s40
  s_lshl_b32 s57, s57, 10
  s_mov_b32 s56, 98304
  ds_read_b128 v[24:27], v12 offset:0
  ds_read_b128 v[28:31], v13 offset:0
  ds_read_b128 v[32:35], v12 offset:512
  ds_read_b128 v[36:39], v13 offset:512
  ds_read_b128 v[40:43], v12 offset:1024
  ds_read_b128 v[44:47], v13 offset:1024
  ds_read_b128 v[48:51], v12 offset:1536
  ds_read_b128 v[52:55], v13 offset:1536
  ds_read_b128 v[56:59], v12 offset:2048
  s_waitcnt vmcnt(11)
  s_waitcnt lgkmcnt(5)
  v_mfma_f32_32x32x16_bf16 v[80:95], v[24:27], a[0:3], 0
  buffer_load_dwordx2 v[64:65], v6, s[28:31], s48 offen offset:0 sc1
  ds_read_b128 v[60:63], v13 offset:2048
  v_mfma_f32_32x32x16_bf16 v[96:111], v[28:31], a[0:3], 0
  buffer_load_dwordx2 v[66:67], v6, s[28:31], s48 offen offset:256 sc1
  ds_read_b128 v[24:27], v12 offset:2560
  s_waitcnt vmcnt(12)
  v_mfma_f32_32x32x16_bf16 v[80:95], v[32:35], a[4:7], v[80:95]
  buffer_load_dwordx2 v[68:69], v6, s[28:31], s48 offen offset:512 sc1
  ds_read_b128 v[28:31], v13 offset:2560
  v_mfma_f32_32x32x16_bf16 v[96:111], v[36:39], a[4:7], v[96:111]
  buffer_load_dwordx2 v[70:71], v6, s[28:31], s48 offen offset:768 sc1
  ds_read_b128 v[32:35], v12 offset:3072
  s_waitcnt vmcnt(13)
  s_waitcnt lgkmcnt(5)
  v_mfma_f32_32x32x16_bf16 v[80:95], v[40:43], a[8:11], v[80:95]
  buffer_load_dwordx4 a[48:51], v3, s[24:27], s45 offen offset:0 sc1
  ds_read_b128 v[36:39], v13 offset:3072
  v_mfma_f32_32x32x16_bf16 v[96:111], v[44:47], a[8:11], v[96:111]
  buffer_load_dwordx4 a[52:55], v3, s[24:27], s45 offen offset:1024 sc1
  ds_read_b128 v[40:43], v12 offset:3584
  s_waitcnt vmcnt(14)
  v_mfma_f32_32x32x16_bf16 v[80:95], v[48:51], a[12:15], v[80:95]
  buffer_load_dwordx4 a[56:59], v3, s[24:27], s45 offen offset:2048 sc1
  ds_read_b128 v[44:47], v13 offset:3584
  v_mfma_f32_32x32x16_bf16 v[96:111], v[52:55], a[12:15], v[96:111]
  buffer_load_dwordx4 a[60:63], v3, s[24:27], s45 offen offset:3072 sc1
  s_add_u32 s45, s45, 4096
  ds_read_b128 v[48:51], v12 offset:4096
  s_waitcnt vmcnt(15)
  s_waitcnt lgkmcnt(5)
  v_mfma_f32_32x32x16_bf16 v[80:95], v[56:59], a[16:19], v[80:95]
  buffer_load_dwordx4 a[64:67], v3, s[24:27], s45 offen offset:0 sc1
  ds_read_b128 v[52:55], v13 offset:4096
  v_mfma_f32_32x32x16_bf16 v[96:111], v[60:63], a[16:19], v[96:111]
  buffer_load_dwordx4 a[68:71], v3, s[24:27], s45 offen offset:1024 sc1
  ds_read_b128 v[56:59], v12 offset:4608
  s_waitcnt vmcnt(16)
  v_mfma_f32_32x32x16_bf16 v[80:95], v[24:27], a[20:23], v[80:95]
  buffer_load_dwordx4 a[72:75], v3, s[24:27], s45 offen offset:2048 sc1
  ds_read_b128 v[60:63], v13 offset:4608
  v_mfma_f32_32x32x16_bf16 v[96:111], v[28:31], a[20:23], v[96:111]
  buffer_load_dwordx4 a[76:79], v3, s[24:27], s45 offen offset:3072 sc1
  s_add_u32 s45, s45, 4096
  ds_read_b128 v[24:27], v12 offset:5120
  s_waitcnt vmcnt(17)
  s_waitcnt lgkmcnt(5)
  v_mfma_f32_32x32x16_bf16 v[80:95], v[32:35], a[24:27], v[80:95]
  buffer_load_dwordx4 a[80:83], v3, s[24:27], s45 offen offset:0 sc1
  ds_read_b128 v[28:31], v13 offset:5120
  v_mfma_f32_32x32x16_bf16 v[96:111], v[36:39], a[24:27], v[96:111]
  buffer_load_dwordx4 a[84:87], v3, s[24:27], s45 offen offset:1024 sc1
  ds_read_b128 v[32:35], v12 offset:5632
  s_waitcnt vmcnt(18)
  v_mfma_f32_32x32x16_bf16 v[80:95], v[40:43], a[28:31], v[80:95]
  buffer_load_dwordx4 a[88:91], v3, s[24:27], s45 offen offset:2048 sc1
  ds_read_b128 v[36:39], v13 offset:5632
  v_mfma_f32_32x32x16_bf16 v[96:111], v[44:47], a[28:31], v[96:111]
  buffer_load_dwordx4 a[92:95], v3, s[24:27], s45 offen offset:3072 sc1
  s_add_u32 s45, s45, 4096
  ds_read_b128 v[40:43], v12 offset:6144
  s_waitcnt vmcnt(19)
  s_waitcnt lgkmcnt(5)
  v_mfma_f32_32x32x16_bf16 v[80:95], v[48:51], a[32:35], v[80:95]
  buffer_load_dwordx4 a[96:99], v3, s[24:27], s45 offen offset:0 sc1
  ds_read_b128 v[44:47], v13 offset:6144
  v_mfma_f32_32x32x16_bf16 v[96:111], v[52:55], a[32:35], v[96:111]
  s_barrier
  ds_read_b128 v[48:51], v10 offset:0
  s_waitcnt vmcnt(19)
  v_mfma_f32_32x32x16_bf16 v[80:95], v[56:59], a[36:39], v[80:95]
  buffer_load_dwordx4 a[100:103], v3, s[24:27], s45 offen offset:1024 sc1
  ds_read_b128 v[52:55], v12 offset:6656
  v_mfma_f32_32x32x16_bf16 v[96:111], v[60:63], a[36:39], v[96:111]
  ds_read_b128 v[56:59], v13 offset:6656
  s_waitcnt vmcnt(19)
  s_waitcnt lgkmcnt(5)
  v_mfma_f32_32x32x16_bf16 v[80:95], v[24:27], a[40:43], v[80:95]
  buffer_load_dwordx4 a[104:107], v3, s[24:27], s45 offen offset:2048 sc1
  ds_read_b128 v[60:63], v10 offset:512
  v_mfma_f32_32x32x16_bf16 v[96:111], v[28:31], a[40:43], v[96:111]
  ds_read_b128 v[24:27], v12 offset:7168
  s_waitcnt vmcnt(19)
  v_mfma_f32_32x32x16_bf16 v[80:95], v[32:35], a[44:47], v[80:95]
  buffer_load_dwordx4 a[108:111], v3, s[24:27], s45 offen offset:3072 sc1
  s_add_u32 s45, s45, 4096
  ds_read_b128 v[28:31], v13 offset:7168
  v_mfma_f32_32x32x16_bf16 v[96:111], v[36:39], a[44:47], v[96:111]
  ds_read_b128 v[32:35], v10 offset:1024
  s_waitcnt vmcnt(15)
  s_waitcnt lgkmcnt(5)
  v_mfma_f32_32x32x16_bf16 v[80:95], v[40:43], a[48:51], v[80:95]
  buffer_load_dwordx4 a[112:115], v3, s[24:27], s45 offen offset:0 sc1
  ds_read_b128 v[36:39], v12 offset:7680
  v_mfma_f32_32x32x16_bf16 v[96:111], v[44:47], a[48:51], v[96:111]
  buffer_load_dwordx4 a[116:119], v3, s[24:27], s45 offen offset:1024 sc1
  ds_read_b128 v[40:43], v13 offset:7680
  v_mfma_f32_32x32x16_bf16 v[112:127], v[48:51], a[0:3], 0
  buffer_load_dwordx4 a[120:123], v3, s[24:27], s45 offen offset:2048 sc1
  ds_read_b128 v[44:47], v10 offset:1536
  s_waitcnt vmcnt(17)
  v_mfma_f32_32x32x16_bf16 v[80:95], v[52:55], a[52:55], v[80:95]
  buffer_load_dwordx4 a[124:127], v3, s[24:27], s45 offen offset:3072 sc1
  s_add_u32 s45, s45, 4096
  ds_read_b128 v[48:51], v12 offset:8192
  s_waitcnt lgkmcnt(5)
  v_mfma_f32_32x32x16_bf16 v[96:111], v[56:59], a[52:55], v[96:111]
  buffer_load_dwordx4 a[128:131], v3, s[24:27], s45 offen offset:0 sc1
  ds_read_b128 v[52:55], v13 offset:8192
  v_mfma_f32_32x32x16_bf16 v[112:127], v[60:63], a[4:7], v[112:127]
  buffer_load_dwordx4 a[132:135], v3, s[24:27], s45 offen offset:1024 sc1
  ds_read_b128 v[56:59], v10 offset:2048
  s_waitcnt vmcnt(19)
  v_mfma_f32_32x32x16_bf16 v[80:95], v[24:27], a[56:59], v[80:95]
  buffer_load_dwordx4 a[136:139], v3, s[24:27], s45 offen offset:2048 sc1
  v_add_f32 v64, v64, v66
  ds_read_b128 v[60:63], v12 offset:8704
  v_mfma_f32_32x32x16_bf16 v[96:111], v[28:31], a[56:59], v[96:111]
  v_add_f32 v65, v65, v67
  v_add_f32 v68, v68, v70
  ds_read_b128 v[24:27], v13 offset:8704
  s_waitcnt lgkmcnt(5)
  v_mfma_f32_32x32x16_bf16 v[112:127], v[32:35], a[8:11], v[112:127]
  v_add_f32 v69, v69, v71
  v_add_f32 v64, v64, v68
  ds_read_b128 v[28:31], v10 offset:2560
  s_waitcnt vmcnt(19)
  v_mfma_f32_32x32x16_bf16 v[80:95], v[36:39], a[60:63], v[80:95]
  buffer_load_dwordx4 a[140:143], v3, s[24:27], s45 offen offset:3072 sc1
  s_add_u32 s45, s45, 4096
  v_add_f32 v65, v65, v69
  ds_read_b128 v[32:35], v12 offset:9216
  v_mfma_f32_32x32x16_bf16 v[96:111], v[40:43], a[60:63], v[96:111]
  v_mov_b32 v66, v64
  v_mov_b32 v67, v65
  ds_read_b128 v[36:39], v13 offset:9216
  v_mfma_f32_32x32x16_bf16 v[112:127], v[44:47], a[12:15], v[112:127]
  v_permlane32_swap_b32 v64, v66
  ds_read_b128 v[40:43], v10 offset:3072
  s_waitcnt vmcnt(19)
  s_waitcnt lgkmcnt(5)
  v_mfma_f32_32x32x16_bf16 v[80:95], v[48:51], a[64:67], v[80:95]
  buffer_load_dwordx4 a[144:147], v3, s[24:27], s45 offen offset:0 sc1
  v_permlane32_swap_b32 v65, v67
  ds_read_b128 v[44:47], v12 offset:9728
  v_mfma_f32_32x32x16_bf16 v[96:111], v[52:55], a[64:67], v[96:111]
  v_add_f32 v64, v64, v66
  v_add_f32 v65, v65, v67
  v_mul_f32 v64, 0xbacccccd, v64
  ds_read_b128 v[48:51], v13 offset:9728
  v_mfma_f32_32x32x16_bf16 v[112:127], v[56:59], a[16:19], v[112:127]
  v_mul_f32 v65, 0x3acccccd, v65
  v_fma_f32 v65, -v64, v64, v65
  ds_read_b128 v[52:55], v10 offset:3584
  s_waitcnt vmcnt(19)
  v_mfma_f32_32x32x16_bf16 v[80:95], v[60:63], a[68:71], v[80:95]
  buffer_load_dwordx4 a[148:151], v3, s[24:27], s45 offen offset:1024 sc1
  ds_read_b128 v[56:59], v12 offset:10240
  s_waitcnt lgkmcnt(5)
  v_mfma_f32_32x32x16_bf16 v[96:111], v[24:27], a[68:71], v[96:111]
  v_max_f32 v65, 0, v65
  v_add_f32 v65, 0x3727c5ac, v65
  v_cvt_pk_bf16_f32 v66, v64, v64
  ds_read_b128 v[60:63], v13 offset:10240
  v_mfma_f32_32x32x16_bf16 v[112:127], v[28:31], a[20:23], v[112:127]
  v_rsq_f32 v65, v65
  ds_read_b128 v[24:27], v10 offset:4096
  s_waitcnt vmcnt(19)
  v_mfma_f32_32x32x16_bf16 v[80:95], v[32:35], a[72:75], v[80:95]
  buffer_load_dwordx4 a[152:155], v3, s[24:27], s45 offen offset:2048 sc1
  v_lshlrev_b32 v66, 16, v66
  ds_read_b128 v[28:31], v12 offset:10752
  v_mfma_f32_32x32x16_bf16 v[96:111], v[36:39], a[72:75], v[96:111]
  v_sub_f32 v67, v64, v66
  v_cvt_pk_bf16_f32 v16, v66, v67
  ds_read_b128 v[32:35], v13 offset:10752
  s_waitcnt lgkmcnt(5)
  v_mfma_f32_32x32x16_bf16 v[112:127], v[40:43], a[24:27], v[112:127]
  v_mul_f32 v22, v65, v65
  v_mov_b32 v17, v16
  ds_read_b128 v[36:39], v10 offset:4608
  s_waitcnt vmcnt(19)
  v_mfma_f32_32x32x16_bf16 v[80:95], v[44:47], a[76:79], v[80:95]
  buffer_load_dwordx4 a[156:159], v3, s[24:27], s45 offen offset:3072 sc1
  s_add_u32 s45, s45, 4096
  v_mov_b32 v18, v16
  ds_read_b128 v[40:43], v12 offset:11264
  v_mfma_f32_32x32x16_bf16 v[96:111], v[48:51], a[76:79], v[96:111]
  v_mov_b32 v19, v16
  v_mul_f32 v14, 0xc0135761, v65
  v_mul_f32 v15, 0xbdd2d3e8, v65
  ds_read_b128 v[44:47], v13 offset:11264
  v_mfma_f32_32x32x16_bf16 v[112:127], v[52:55], a[28:31], v[112:127]
  v_mul_f32 v15, v15, v22
  ds_read_b128 v[48:51], v10 offset:5120
  s_waitcnt vmcnt(19)
  s_waitcnt lgkmcnt(5)
  v_mfma_f32_32x32x16_bf16 v[80:95], v[56:59], a[80:83], v[80:95]
  s_add_u32 m0, s3, 40960
  s_nop 0
  buffer_load_dwordx4 v3, s[16:19], m0 offen offset:0 sc1 lds
  v_lshlrev_b32 v21, 2, v5
  ds_read_b128 v[52:55], v12 offset:11776
  v_mfma_f32_32x32x16_bf16 v[96:111], v[60:63], a[80:83], v[96:111]
  buffer_store_dword v22, v21, s[32:35], s52 offen sc1
  ds_read_b128 v[56:59], v13 offset:11776
  v_mfma_f32_32x32x16_bf16 v[112:127], v[24:27], a[32:35], v[112:127]
  ds_read_b128 v[60:63], v10 offset:5632
  s_waitcnt vmcnt(20)
  v_mfma_f32_32x32x16_bf16 v[80:95], v[28:31], a[84:87], v[80:95]
  ds_read_b128 v[24:27], v12 offset:12288
  s_waitcnt lgkmcnt(5)
  v_mfma_f32_32x32x16_bf16 v[96:111], v[32:35], a[84:87], v[96:111]
  ds_read_b128 v[28:31], v13 offset:12288
  v_mfma_f32_32x32x16_bf16 v[112:127], v[36:39], a[36:39], v[112:127]
  ds_read_b128 v[32:35], v10 offset:6144
  s_waitcnt vmcnt(19)
  v_mfma_f32_32x32x16_bf16 v[80:95], v[40:43], a[88:91], v[80:95]
  buffer_load_dwordx4 v3, s[16:19], m0 offen offset:1024 sc1 lds
  ds_read_b128 v[36:39], v12 offset:12800
  v_mfma_f32_32x32x16_bf16 v[96:111], v[44:47], a[88:91], v[96:111]
  ds_read_b128 v[40:43], v13 offset:12800
  s_waitcnt lgkmcnt(5)
  v_mfma_f32_32x32x16_bf16 v[112:127], v[48:51], a[40:43], v[112:127]
  ds_read_b128 v[44:47], v10 offset:6656
  s_waitcnt vmcnt(19)
  v_mfma_f32_32x32x16_bf16 v[80:95], v[52:55], a[92:95], v[80:95]
  buffer_load_dwordx4 v3, s[16:19], m0 offen offset:2048 sc1 lds
  ds_read_b128 v[48:51], v12 offset:13312
  v_mfma_f32_32x32x16_bf16 v[96:111], v[56:59], a[92:95], v[96:111]
  ds_read_b128 v[52:55], v13 offset:13312
  v_mfma_f32_32x32x16_bf16 v[112:127], v[60:63], a[44:47], v[112:127]
  ds_read_b128 v[56:59], v10 offset:7168
  s_waitcnt vmcnt(19)
  s_waitcnt lgkmcnt(5)
  v_mfma_f32_32x32x16_bf16 v[80:95], v[24:27], a[96:99], v[80:95]
  buffer_load_dwordx4 v3, s[16:19], m0 offen offset:3072 sc1 lds
  ds_read_b128 v[60:63], v12 offset:13824
  v_mfma_f32_32x32x16_bf16 v[96:111], v[28:31], a[96:99], v[96:111]
  ds_read_b128 v[24:27], v13 offset:13824
  v_mfma_f32_32x32x16_bf16 v[112:127], v[32:35], a[48:51], v[112:127]
  ds_read_b128 v[28:31], v10 offset:7680
  s_waitcnt vmcnt(19)
  v_mfma_f32_32x32x16_bf16 v[80:95], v[36:39], a[100:103], v[80:95]
  s_add_u32 m0, s3, 45056
  s_nop 0
  buffer_load_dwordx4 v3, s[16:19], m0 offen offset:0 sc1 lds
  ds_read_b128 v[32:35], v12 offset:14336
  s_waitcnt lgkmcnt(5)
  v_mfma_f32_32x32x16_bf16 v[96:111], v[40:43], a[100:103], v[96:111]
  ds_read_b128 v[36:39], v13 offset:14336
  v_mfma_f32_32x32x16_bf16 v[112:127], v[44:47], a[52:55], v[112:127]
  ds_read_b128 v[40:43], v10 offset:8192
  s_waitcnt vmcnt(19)
  v_mfma_f32_32x32x16_bf16 v[80:95], v[48:51], a[104:107], v[80:95]
  buffer_load_dwordx4 v3, s[16:19], m0 offen offset:1024 sc1 lds
  ds_read_b128 v[44:47], v12 offset:14848
  v_mfma_f32_32x32x16_bf16 v[96:111], v[52:55], a[104:107], v[96:111]
  ds_read_b128 v[48:51], v13 offset:14848
  s_waitcnt lgkmcnt(5)
  v_mfma_f32_32x32x16_bf16 v[112:127], v[56:59], a[56:59], v[112:127]
  ds_read_b128 v[52:55], v10 offset:8704
  s_waitcnt vmcnt(19)
  v_mfma_f32_32x32x16_bf16 v[80:95], v[60:63], a[108:111], v[80:95]
  buffer_load_dwordx4 v3, s[16:19], m0 offen offset:2048 sc1 lds
  ds_read_b128 v[56:59], v12 offset:15360
  v_mfma_f32_32x32x16_bf16 v[96:111], v[24:27], a[108:111], v[96:111]
  ds_read_b128 v[60:63], v13 offset:15360
  v_mfma_f32_32x32x16_bf16 v[112:127], v[28:31], a[60:63], v[112:127]
  ds_read_b128 v[24:27], v10 offset:9216
  s_waitcnt vmcnt(19)
  s_waitcnt lgkmcnt(5)
  v_mfma_f32_32x32x16_bf16 v[80:95], v[32:35], a[112:115], v[80:95]
  buffer_load_dwordx4 v3, s[16:19], m0 offen offset:3072 sc1 lds
  ds_read_b128 v[28:31], v12 offset:15872
  v_mfma_f32_32x32x16_bf16 v[96:111], v[36:39], a[112:115], v[96:111]
  ds_read_b128 v[32:35], v13 offset:15872
  v_mfma_f32_32x32x16_bf16 v[112:127], v[40:43], a[64:67], v[112:127]
  ds_read_b128 v[36:39], v10 offset:9728
  s_waitcnt vmcnt(19)
  v_mfma_f32_32x32x16_bf16 v[80:95], v[44:47], a[116:119], v[80:95]
  s_add_u32 m0, s3, 49152
  s_nop 0
  buffer_load_dwordx4 v3, s[16:19], m0 offen offset:0 sc1 lds
  ds_read_b128 v[40:43], v12 offset:16384
  s_waitcnt lgkmcnt(5)
  v_mfma_f32_32x32x16_bf16 v[96:111], v[48:51], a[116:119], v[96:111]
  ds_read_b128 v[44:47], v13 offset:16384
  v_mfma_f32_32x32x16_bf16 v[112:127], v[52:55], a[68:71], v[112:127]
  ds_read_b128 v[48:51], v10 offset:10240
  s_waitcnt vmcnt(19)
  v_mfma_f32_32x32x16_bf16 v[80:95], v[56:59], a[120:123], v[80:95]
  buffer_load_dwordx4 v3, s[16:19], m0 offen offset:1024 sc1 lds
  ds_read_b128 v[52:55], v12 offset:16896
  v_mfma_f32_32x32x16_bf16 v[96:111], v[60:63], a[120:123], v[96:111]
  ds_read_b128 v[56:59], v13 offset:16896
  s_waitcnt lgkmcnt(5)
  v_mfma_f32_32x32x16_bf16 v[112:127], v[24:27], a[72:75], v[112:127]
  ds_read_b128 v[60:63], v10 offset:10752
  s_waitcnt vmcnt(19)
  v_mfma_f32_32x32x16_bf16 v[80:95], v[28:31], a[124:127], v[80:95]
  s_add_u32 s23, s22, 116736
  buffer_load_dwordx4 a[220:223], v3, s[64:67], s23 offen sc1
  ds_read_b128 v[24:27], v12 offset:17408
  v_mfma_f32_32x32x16_bf16 v[96:111], v[32:35], a[124:127], v[96:111]
  ds_read_b128 v[28:31], v13 offset:17408
  v_mfma_f32_32x32x16_bf16 v[112:127], v[36:39], a[76:79], v[112:127]
  ds_read_b128 v[32:35], v10 offset:11264
  s_waitcnt vmcnt(19)
  s_waitcnt lgkmcnt(5)
  v_mfma_f32_32x32x16_bf16 v[80:95], v[40:43], a[128:131], v[80:95]
  s_add_u32 s23, s22, 174080
  buffer_load_dwordx4 a[224:227], v3, s[64:67], s23 offen sc1
  ds_read_b128 v[36:39], v12 offset:17920
  v_mfma_f32_32x32x16_bf16 v[96:111], v[44:47], a[128:131], v[96:111]
  ds_read_b128 v[40:43], v13 offset:17920
  v_mfma_f32_32x32x16_bf16 v[112:127], v[48:51], a[80:83], v[112:127]
  ds_read_b128 v[44:47], v10 offset:11776
  s_waitcnt vmcnt(19)
  v_mfma_f32_32x32x16_bf16 v[80:95], v[52:55], a[132:135], v[80:95]
  s_add_u32 s23, s22, 231424
  buffer_load_dwordx4 a[228:231], v3, s[64:67], s23 offen sc1
  ds_read_b128 v[48:51], v12 offset:18432
  s_waitcnt lgkmcnt(5)
  v_mfma_f32_32x32x16_bf16 v[96:111], v[56:59], a[132:135], v[96:111]
  ds_read_b128 v[52:55], v13 offset:18432
  v_mfma_f32_32x32x16_bf16 v[112:127], v[60:63], a[84:87], v[112:127]
  ds_read_b128 v[56:59], v10 offset:12288
  s_waitcnt vmcnt(19)
  v_mfma_f32_32x32x16_bf16 v[80:95], v[24:27], a[136:139], v[80:95]
  s_add_u32 s23, s22, 3072
  buffer_load_dwordx4 a[232:235], v3, s[64:67], s23 offen sc1
  ds_read_b128 v[60:63], v12 offset:18944
  v_mfma_f32_32x32x16_bf16 v[96:111], v[28:31], a[136:139], v[96:111]
  ds_read_b128 v[24:27], v13 offset:18944
  s_waitcnt lgkmcnt(5)
  v_mfma_f32_32x32x16_bf16 v[112:127], v[32:35], a[88:91], v[112:127]
  ds_read_b128 v[28:31], v10 offset:12800
  s_waitcnt vmcnt(19)
  v_mfma_f32_32x32x16_bf16 v[80:95], v[36:39], a[140:143], v[80:95]
  s_add_u32 s23, s22, 60416
  buffer_load_dwordx4 a[236:239], v3, s[64:67], s23 offen sc1
  ds_read_b128 v[32:35], v12 offset:19456
  v_mfma_f32_32x32x16_bf16 v[96:111], v[40:43], a[140:143], v[96:111]
  ds_read_b128 v[36:39], v13 offset:19456
  v_mfma_f32_32x32x16_bf16 v[112:127], v[44:47], a[92:95], v[112:127]
  ds_read_b128 v[40:43], v10 offset:13312
  s_waitcnt vmcnt(19)
  s_waitcnt lgkmcnt(5)
  v_mfma_f32_32x32x16_bf16 v[80:95], v[48:51], a[144:147], v[80:95]
  s_add_u32 s23, s22, 117760
  buffer_load_dwordx4 a[240:243], v3, s[64:67], s23 offen sc1
  ds_read_b128 v[44:47], v12 offset:19968
  v_mfma_f32_32x32x16_bf16 v[96:111], v[52:55], a[144:147], v[96:111]
  ds_read_b128 v[48:51], v13 offset:19968
  v_mfma_f32_32x32x16_bf16 v[112:127], v[56:59], a[96:99], v[112:127]
  ds_read_b128 v[52:55], v10 offset:13824
  s_waitcnt vmcnt(19)
  v_mfma_f32_32x32x16_bf16 v[80:95], v[60:63], a[148:151], v[80:95]
  s_add_u32 s23, s22, 175104
  buffer_load_dwordx4 a[244:247], v3, s[64:67], s23 offen sc1
  ds_read_b128 v[56:59], v10 offset:14336
  s_waitcnt lgkmcnt(5)
  v_mfma_f32_32x32x16_bf16 v[96:111], v[24:27], a[148:151], v[96:111]
  ds_read_b128 v[60:63], v10 offset:14848
  v_mfma_f32_32x32x16_bf16 v[112:127], v[28:31], a[100:103], v[112:127]
  ds_read_b128 v[24:27], v10 offset:15360
  s_waitcnt vmcnt(19)
  v_mfma_f32_32x32x16_bf16 v[80:95], v[32:35], a[152:155], v[80:95]
  s_add_u32 s23, s22, 232448
  buffer_load_dwordx4 a[248:251], v3, s[64:67], s23 offen sc1
  ds_read_b128 v[28:31], v10 offset:15872
  v_mfma_f32_32x32x16_bf16 v[96:111], v[36:39], a[152:155], v[96:111]
  ds_read_b128 v[32:35], v10 offset:16384
  s_waitcnt lgkmcnt(5)
  v_mfma_f32_32x32x16_bf16 v[112:127], v[40:43], a[104:107], v[112:127]
  ds_read_b128 v[36:39], v10 offset:16896
  s_waitcnt vmcnt(19)
  v_mfma_f32_32x32x16_bf16 v[80:95], v[44:47], a[156:159], v[80:95]
  s_add_u32 s23, s22, 4096
  buffer_load_dwordx4 a[252:255], v3, s[64:67], s23 offen sc1
  ds_read_b128 v[40:43], v10 offset:17408
  v_mfma_f32_32x32x16_bf16 v[96:111], v[48:51], a[156:159], v[96:111]
  v_mfma_f32_32x32x16_bf16 v[80:95], a[160:163], v[16:19], v[80:95]
  v_mfma_f32_32x32x16_bf16 v[96:111], a[164:167], v[16:19], v[96:111]
  s_nop 10
  v_pk_mul_f32 v[64:65], v[80:81], v[80:81]
  v_pk_mul_f32 v[66:67], v[82:83], v[82:83]
  v_pk_mul_f32 v[68:69], v[84:85], v[84:85]
  v_pk_mul_f32 v[70:71], v[86:87], v[86:87]
  v_pk_fma_f32 v[64:65], v[64:65], v[14:15], v[14:15] op_sel:[0,1,0] op_sel_hi:[1,1,0]
  v_pk_fma_f32 v[66:67], v[66:67], v[14:15], v[14:15] op_sel:[0,1,0] op_sel_hi:[1,1,0]
  v_pk_fma_f32 v[68:69], v[68:69], v[14:15], v[14:15] op_sel:[0,1,0] op_sel_hi:[1,1,0]
  v_pk_fma_f32 v[70:71], v[70:71], v[14:15], v[14:15] op_sel:[0,1,0] op_sel_hi:[1,1,0]
  v_pk_mul_f32 v[64:65], v[64:65], v[80:81]
  v_pk_mul_f32 v[66:67], v[66:67], v[82:83]
  v_pk_mul_f32 v[68:69], v[68:69], v[84:85]
  v_pk_mul_f32 v[70:71], v[70:71], v[86:87]
  v_exp_f32 v64, v64
  v_exp_f32 v65, v65
  v_exp_f32 v66, v66
  v_exp_f32 v67, v67
  v_exp_f32 v68, v68
  v_exp_f32 v69, v69
  v_exp_f32 v70, v70
  v_exp_f32 v71, v71
  v_pk_mul_f32 v[80:81], v[80:81], v[88:89]
  v_pk_mul_f32 v[82:83], v[82:83], v[90:91]
  v_pk_mul_f32 v[84:85], v[84:85], v[92:93]
  v_pk_mul_f32 v[86:87], v[86:87], v[94:95]
  v_pk_add_f32 v[64:65], v[64:65], 1.0 op_sel_hi:[1,0]
  v_pk_add_f32 v[66:67], v[66:67], 1.0 op_sel_hi:[1,0]
  v_pk_add_f32 v[68:69], v[68:69], 1.0 op_sel_hi:[1,0]
  v_pk_add_f32 v[70:71], v[70:71], 1.0 op_sel_hi:[1,0]
  v_rcp_f32 v64, v64
  v_rcp_f32 v65, v65
  v_rcp_f32 v66, v66
  v_rcp_f32 v67, v67
  v_rcp_f32 v68, v68
  v_rcp_f32 v69, v69
  v_rcp_f32 v70, v70
  v_rcp_f32 v71, v71
  v_pk_mul_f32 v[80:81], v[80:81], v[64:65]
  v_pk_mul_f32 v[82:83], v[82:83], v[66:67]
  v_pk_mul_f32 v[84:85], v[84:85], v[68:69]
  v_pk_mul_f32 v[86:87], v[86:87], v[70:71]
  v_cvt_pk_bf16_f32 v72, v80, v81
  v_cvt_pk_bf16_f32 v73, v82, v83
  v_cvt_pk_bf16_f32 v74, v84, v85
  v_cvt_pk_bf16_f32 v75, v86, v87
  buffer_store_dwordx4 v[72:75], v20, s[36:39], s50 offen offset:0 sc1
  v_pk_mul_f32 v[64:65], v[96:97], v[96:97]
  v_pk_mul_f32 v[66:67], v[98:99], v[98:99]
  v_pk_mul_f32 v[68:69], v[100:101], v[100:101]
  v_pk_mul_f32 v[70:71], v[102:103], v[102:103]
  v_pk_fma_f32 v[64:65], v[64:65], v[14:15], v[14:15] op_sel:[0,1,0] op_sel_hi:[1,1,0]
  v_pk_fma_f32 v[66:67], v[66:67], v[14:15], v[14:15] op_sel:[0,1,0] op_sel_hi:[1,1,0]
  v_pk_fma_f32 v[68:69], v[68:69], v[14:15], v[14:15] op_sel:[0,1,0] op_sel_hi:[1,1,0]
  v_pk_fma_f32 v[70:71], v[70:71], v[14:15], v[14:15] op_sel:[0,1,0] op_sel_hi:[1,1,0]
  v_pk_mul_f32 v[64:65], v[64:65], v[96:97]
  v_pk_mul_f32 v[66:67], v[66:67], v[98:99]
  v_pk_mul_f32 v[68:69], v[68:69], v[100:101]
  v_pk_mul_f32 v[70:71], v[70:71], v[102:103]
  v_exp_f32 v64, v64
  v_exp_f32 v65, v65
  v_exp_f32 v66, v66
  v_exp_f32 v67, v67
  v_exp_f32 v68, v68
  v_exp_f32 v69, v69
  v_exp_f32 v70, v70
  v_exp_f32 v71, v71
  v_pk_mul_f32 v[96:97], v[96:97], v[104:105]
  v_pk_mul_f32 v[98:99], v[98:99], v[106:107]
  v_pk_mul_f32 v[100:101], v[100:101], v[108:109]
  v_pk_mul_f32 v[102:103], v[102:103], v[110:111]
  v_pk_add_f32 v[64:65], v[64:65], 1.0 op_sel_hi:[1,0]
  v_pk_add_f32 v[66:67], v[66:67], 1.0 op_sel_hi:[1,0]
  v_pk_add_f32 v[68:69], v[68:69], 1.0 op_sel_hi:[1,0]
  v_pk_add_f32 v[70:71], v[70:71], 1.0 op_sel_hi:[1,0]
  v_rcp_f32 v64, v64
  v_rcp_f32 v65, v65
  v_rcp_f32 v66, v66
  v_rcp_f32 v67, v67
  v_rcp_f32 v68, v68
  v_rcp_f32 v69, v69
  v_rcp_f32 v70, v70
  v_rcp_f32 v71, v71
  v_pk_mul_f32 v[96:97], v[96:97], v[64:65]
  v_pk_mul_f32 v[98:99], v[98:99], v[66:67]
  v_pk_mul_f32 v[100:101], v[100:101], v[68:69]
  v_pk_mul_f32 v[102:103], v[102:103], v[70:71]
  v_cvt_pk_bf16_f32 v76, v96, v97
  v_cvt_pk_bf16_f32 v77, v98, v99
  v_cvt_pk_bf16_f32 v78, v100, v101
  v_cvt_pk_bf16_f32 v79, v102, v103
  buffer_store_dwordx4 v[76:79], v20, s[36:39], s50 offen offset:2048 sc1
  s_add_u32 s50, s50, 4096
  ds_read_b128 v[44:47], v10 offset:17920
  v_mfma_f32_32x32x16_bf16 v[112:127], v[52:55], a[108:111], v[112:127]
  buffer_load_dwordx4 a[164:167], v0, s[12:15], s47 offen offset:0 sc1
  ds_read_b128 v[48:51], v10 offset:18432
  s_waitcnt lgkmcnt(5)
  v_mfma_f32_32x32x16_bf16 v[112:127], v[56:59], a[112:115], v[112:127]
  ds_read_b128 v[52:55], v10 offset:18944
  v_mfma_f32_32x32x16_bf16 v[112:127], v[60:63], a[116:119], v[112:127]
  buffer_load_dwordx4 a[160:163], v0, s[12:15], s46 offen offset:3072 sc1
  ds_read_b128 v[56:59], v10 offset:19456
  v_mfma_f32_32x32x16_bf16 v[112:127], v[24:27], a[120:123], v[112:127]
  ds_read_b128 v[60:63], v10 offset:19968
  v_mfma_f32_32x32x16_bf16 v[112:127], v[28:31], a[124:127], v[112:127]
  s_add_u32 s23, s22, 61440
  buffer_load_dwordx4 v[252:255], v3, s[64:67], s23 offen sc1
  s_waitcnt vmcnt(14)
  s_barrier
  ds_read_b128 v[24:27], v11 offset:0
  s_waitcnt lgkmcnt(5)
  v_mfma_f32_32x32x16_bf16 v[112:127], v[32:35], a[128:131], v[112:127]
  ds_read_b128 v[28:31], v11 offset:512
  v_mfma_f32_32x32x16_bf16 v[112:127], v[36:39], a[132:135], v[112:127]
  s_add_u32 m0, s3, 81920
  s_nop 0
  buffer_load_dwordx4 v3, s[16:19], m0 offen offset:0 sc1 lds
  ds_read_b128 v[32:35], v11 offset:1024
  v_mfma_f32_32x32x16_bf16 v[112:127], v[40:43], a[136:139], v[112:127]
  ds_read_b128 v[36:39], v11 offset:1536
  v_mfma_f32_32x32x16_bf16 v[112:127], v[44:47], a[140:143], v[112:127]
  buffer_load_dwordx4 v3, s[16:19], m0 offen offset:1024 sc1 lds
  ds_read_b128 v[40:43], v11 offset:2048
  s_waitcnt lgkmcnt(5)
  v_mfma_f32_32x32x16_bf16 v[112:127], v[48:51], a[144:147], v[112:127]
  ds_read_b128 v[44:47], v11 offset:2560
  v_mfma_f32_32x32x16_bf16 v[112:127], v[52:55], a[148:151], v[112:127]
  buffer_load_dwordx4 v3, s[16:19], m0 offen offset:2048 sc1 lds
  ds_read_b128 v[48:51], v11 offset:3072
  v_mfma_f32_32x32x16_bf16 v[112:127], v[56:59], a[152:155], v[112:127]
  ds_read_b128 v[52:55], v11 offset:3584
  v_mfma_f32_32x32x16_bf16 v[112:127], v[60:63], a[156:159], v[112:127]
  buffer_load_dwordx4 v3, s[16:19], m0 offen offset:3072 sc1 lds
  v_mfma_f32_32x32x16_bf16 v[112:127], a[168:171], v[16:19], v[112:127]
  s_nop 11
  v_pk_mul_f32 v[64:65], v[112:113], v[112:113]
  v_pk_mul_f32 v[66:67], v[114:115], v[114:115]
  v_pk_mul_f32 v[68:69], v[116:117], v[116:117]
  v_pk_mul_f32 v[70:71], v[118:119], v[118:119]
  v_pk_fma_f32 v[64:65], v[64:65], v[14:15], v[14:15] op_sel:[0,1,0] op_sel_hi:[1,1,0]
  v_pk_fma_f32 v[66:67], v[66:67], v[14:15], v[14:15] op_sel:[0,1,0] op_sel_hi:[1,1,0]
  v_pk_fma_f32 v[68:69], v[68:69], v[14:15], v[14:15] op_sel:[0,1,0] op_sel_hi:[1,1,0]
  v_pk_fma_f32 v[70:71], v[70:71], v[14:15], v[14:15] op_sel:[0,1,0] op_sel_hi:[1,1,0]
  v_pk_mul_f32 v[64:65], v[64:65], v[112:113]
  v_pk_mul_f32 v[66:67], v[66:67], v[114:115]
  v_pk_mul_f32 v[68:69], v[68:69], v[116:117]
  v_pk_mul_f32 v[70:71], v[70:71], v[118:119]
  s_add_u32 m0, s3, 86016
  s_nop 0
  buffer_load_dwordx4 v3, s[16:19], m0 offen offset:0 sc1 lds
  v_exp_f32 v64, v64
  v_exp_f32 v65, v65
  v_exp_f32 v66, v66
  v_exp_f32 v67, v67
  v_exp_f32 v68, v68
  v_exp_f32 v69, v69
  v_exp_f32 v70, v70
  v_exp_f32 v71, v71
  v_pk_mul_f32 v[112:113], v[112:113], v[120:121]
  v_pk_mul_f32 v[114:115], v[114:115], v[122:123]
  v_pk_mul_f32 v[116:117], v[116:117], v[124:125]
  v_pk_mul_f32 v[118:119], v[118:119], v[126:127]
  buffer_load_dwordx4 v3, s[16:19], m0 offen offset:1024 sc1 lds
  v_pk_add_f32 v[64:65], v[64:65], 1.0 op_sel_hi:[1,0]
  v_pk_add_f32 v[66:67], v[66:67], 1.0 op_sel_hi:[1,0]
  v_pk_add_f32 v[68:69], v[68:69], 1.0 op_sel_hi:[1,0]
  v_pk_add_f32 v[70:71], v[70:71], 1.0 op_sel_hi:[1,0]
  v_rcp_f32 v64, v64
  v_rcp_f32 v65, v65
  v_rcp_f32 v66, v66
  v_rcp_f32 v67, v67
  v_rcp_f32 v68, v68
  v_rcp_f32 v69, v69
  v_rcp_f32 v70, v70
  v_rcp_f32 v71, v71
  buffer_load_dwordx4 v3, s[16:19], m0 offen offset:2048 sc1 lds
  v_pk_mul_f32 v[112:113], v[112:113], v[64:65]
  v_pk_mul_f32 v[114:115], v[114:115], v[66:67]
  v_pk_mul_f32 v[116:117], v[116:117], v[68:69]
  v_pk_mul_f32 v[118:119], v[118:119], v[70:71]
  v_cvt_pk_bf16_f32 v72, v112, v113
  v_cvt_pk_bf16_f32 v73, v114, v115
  v_cvt_pk_bf16_f32 v74, v116, v117
  v_cvt_pk_bf16_f32 v75, v118, v119
  buffer_store_dwordx4 v[72:75], v20, s[36:39], s50 offen offset:0 sc1
  ds_read_b128 v[56:59], v11 offset:4096
  s_waitcnt lgkmcnt(5)
  v_mfma_f32_32x32x16_bf16 v[80:95], v[24:27], a[0:3], 0
  ds_read_b128 v[60:63], v11 offset:4608
  v_mfma_f32_32x32x16_bf16 v[80:95], v[28:31], a[4:7], v[80:95]
  buffer_load_dwordx4 v3, s[16:19], m0 offen offset:3072 sc1 lds
  ds_read_b128 v[24:27], v11 offset:5120
  v_mfma_f32_32x32x16_bf16 v[80:95], v[32:35], a[8:11], v[80:95]
  ds_read_b128 v[28:31], v11 offset:5632
  v_mfma_f32_32x32x16_bf16 v[80:95], v[36:39], a[12:15], v[80:95]
  s_add_u32 m0, s3, 90112
  s_nop 0
  buffer_load_dwordx4 v3, s[16:19], m0 offen offset:0 sc1 lds
  ds_read_b128 v[32:35], v11 offset:6144
  s_waitcnt lgkmcnt(5)
  v_mfma_f32_32x32x16_bf16 v[80:95], v[40:43], a[16:19], v[80:95]
  ds_read_b128 v[36:39], v11 offset:6656
  v_mfma_f32_32x32x16_bf16 v[80:95], v[44:47], a[20:23], v[80:95]
  buffer_load_dwordx4 v3, s[16:19], m0 offen offset:1024 sc1 lds
  ds_read_b128 v[40:43], v11 offset:7168
  v_mfma_f32_32x32x16_bf16 v[80:95], v[48:51], a[24:27], v[80:95]
  ds_read_b128 v[44:47], v11 offset:7680
  v_mfma_f32_32x32x16_bf16 v[80:95], v[52:55], a[28:31], v[80:95]
  s_add_u32 m0, s3, 122880
  s_nop 0
  buffer_load_dwordx4 v3, s[16:19], m0 offen offset:0 sc1 lds
  ds_read_b128 v[48:51], v11 offset:8192
  s_waitcnt lgkmcnt(5)
  v_mfma_f32_32x32x16_bf16 v[80:95], v[56:59], a[32:35], v[80:95]
  ds_read_b128 v[52:55], v11 offset:8704
  v_mfma_f32_32x32x16_bf16 v[80:95], v[60:63], a[36:39], v[80:95]
  buffer_load_dwordx4 v3, s[16:19], m0 offen offset:1024 sc1 lds
  ds_read_b128 v[56:59], v11 offset:9216
  v_mfma_f32_32x32x16_bf16 v[80:95], v[24:27], a[40:43], v[80:95]
  ds_read_b128 v[60:63], v11 offset:9728
  v_mfma_f32_32x32x16_bf16 v[80:95], v[28:31], a[44:47], v[80:95]
  buffer_load_dwordx4 a[168:171], v0, s[12:15], s47 offen offset:1024 sc1
  ds_read_b128 v[24:27], v11 offset:10240
  s_waitcnt lgkmcnt(5)
  v_mfma_f32_32x32x16_bf16 v[80:95], v[32:35], a[48:51], v[80:95]
  ds_read_b128 v[28:31], v11 offset:10752
  v_mfma_f32_32x32x16_bf16 v[80:95], v[36:39], a[52:55], v[80:95]
  buffer_load_dwordx4 v3, s[16:19], m0 offen offset:2048 sc1 lds
  ds_read_b128 v[32:35], v11 offset:11264
  v_mfma_f32_32x32x16_bf16 v[80:95], v[40:43], a[56:59], v[80:95]
  ds_read_b128 v[36:39], v11 offset:11776
  v_mfma_f32_32x32x16_bf16 v[80:95], v[44:47], a[60:63], v[80:95]
  buffer_load_dwordx4 v3, s[16:19], m0 offen offset:3072 sc1 lds
  ds_read_b128 v[40:43], v11 offset:12288
  s_waitcnt lgkmcnt(5)
  v_mfma_f32_32x32x16_bf16 v[80:95], v[48:51], a[64:67], v[80:95]
  ds_read_b128 v[44:47], v11 offset:12800
  v_mfma_f32_32x32x16_bf16 v[80:95], v[52:55], a[68:71], v[80:95]
  s_add_u32 m0, s3, 126976
  s_nop 0
  buffer_load_dwordx4 v3, s[16:19], m0 offen offset:0 sc1 lds
  ds_read_b128 v[48:51], v11 offset:13312
  v_mfma_f32_32x32x16_bf16 v[80:95], v[56:59], a[72:75], v[80:95]
  ds_read_b128 v[52:55], v11 offset:13824
  v_mfma_f32_32x32x16_bf16 v[80:95], v[60:63], a[76:79], v[80:95]
  buffer_load_dwordx4 v3, s[16:19], m0 offen offset:1024 sc1 lds
  ds_read_b128 v[56:59], v11 offset:14336
  s_waitcnt lgkmcnt(5)
  v_mfma_f32_32x32x16_bf16 v[80:95], v[24:27], a[80:83], v[80:95]
  ds_read_b128 v[60:63], v11 offset:14848
  v_mfma_f32_32x32x16_bf16 v[80:95], v[28:31], a[84:87], v[80:95]
  buffer_load_dwordx4 v3, s[16:19], m0 offen offset:2048 sc1 lds
  ds_read_b128 v[24:27], v11 offset:15360
  v_mfma_f32_32x32x16_bf16 v[80:95], v[32:35], a[88:91], v[80:95]
  ds_read_b128 v[28:31], v11 offset:15872
  v_mfma_f32_32x32x16_bf16 v[80:95], v[36:39], a[92:95], v[80:95]
  buffer_load_dwordx4 v3, s[16:19], m0 offen offset:3072 sc1 lds
  ds_read_b128 v[32:35], v11 offset:16384
  s_waitcnt lgkmcnt(5)
  v_mfma_f32_32x32x16_bf16 v[80:95], v[40:43], a[96:99], v[80:95]
  ds_read_b128 v[36:39], v11 offset:16896
  v_mfma_f32_32x32x16_bf16 v[80:95], v[44:47], a[100:103], v[80:95]
  s_add_u32 m0, s3, 131072
  s_nop 0
  buffer_load_dwordx4 v3, s[16:19], m0 offen offset:0 sc1 lds
  ds_read_b128 v[40:43], v11 offset:17408
  v_mfma_f32_32x32x16_bf16 v[80:95], v[48:51], a[104:107], v[80:95]
  ds_read_b128 v[44:47], v11 offset:17920
  v_mfma_f32_32x32x16_bf16 v[80:95], v[52:55], a[108:111], v[80:95]
  buffer_load_dwordx4 v3, s[16:19], m0 offen offset:1024 sc1 lds
  ds_read_b128 v[48:51], v11 offset:18432
  s_waitcnt lgkmcnt(5)
  v_mfma_f32_32x32x16_bf16 v[80:95], v[56:59], a[112:115], v[80:95]
  ds_read_b128 v[52:55], v11 offset:18944
  v_mfma_f32_32x32x16_bf16 v[80:95], v[60:63], a[116:119], v[80:95]
  s_add_u32 s23, s22, 118784
  buffer_load_dwordx4 v[248:251], v3, s[64:67], s23 offen sc1
  ds_read_b128 v[56:59], v11 offset:19456
  v_mfma_f32_32x32x16_bf16 v[80:95], v[24:27], a[120:123], v[80:95]
  ds_read_b128 v[60:63], v11 offset:19968
  v_mfma_f32_32x32x16_bf16 v[80:95], v[28:31], a[124:127], v[80:95]
  s_add_u32 s23, s22, 176128
  buffer_load_dwordx4 v[244:247], v3, s[64:67], s23 offen sc1
  s_waitcnt vmcnt(13)
  s_barrier
  ds_read_b128 v[24:27], v12 offset:0
  s_waitcnt lgkmcnt(5)
  v_mfma_f32_32x32x16_bf16 v[80:95], v[32:35], a[128:131], v[80:95]
  ds_read_b128 v[28:31], v12 offset:512
  v_mfma_f32_32x32x16_bf16 v[80:95], v[36:39], a[132:135], v[80:95]
  s_add_u32 m0, s3, 0
  s_nop 0
  buffer_load_dwordx4 v3, s[68:71], m0 offen offset:0 sc1 lds
  ds_read_b128 v[32:35], v12 offset:1024
  v_mfma_f32_32x32x16_bf16 v[80:95], v[40:43], a[136:139], v[80:95]
  ds_read_b128 v[36:39], v12 offset:1536
  v_mfma_f32_32x32x16_bf16 v[80:95], v[44:47], a[140:143], v[80:95]
  buffer_store_dword v1, v8, s[8:11], s58 offen sc0 sc1
  ds_read_b128 v[40:43], v12 offset:2048
  s_waitcnt lgkmcnt(5)
  v_mfma_f32_32x32x16_bf16 v[80:95], v[48:51], a[144:147], v[80:95]
  ds_read_b128 v[44:47], v12 offset:2560
  v_mfma_f32_32x32x16_bf16 v[80:95], v[52:55], a[148:151], v[80:95]
  buffer_load_dwordx4 v3, s[68:71], m0 offen offset:1024 sc1 lds
  ds_read_b128 v[48:51], v12 offset:3072
  v_mfma_f32_32x32x16_bf16 v[80:95], v[56:59], a[152:155], v[80:95]
  ds_read_b128 v[52:55], v12 offset:3584
  v_mfma_f32_32x32x16_bf16 v[80:95], v[60:63], a[156:159], v[80:95]
  buffer_load_dwordx4 v3, s[68:71], m0 offen offset:2048 sc1 lds
  v_mfma_f32_32x32x16_bf16 v[80:95], a[160:163], v[16:19], v[80:95]
  ds_read_b128 v[56:59], v12 offset:4096
  s_waitcnt lgkmcnt(5)
  v_mfma_f32_32x32x16_bf16 v[96:111], v[24:27], a[0:3], 0
  ds_read_b128 v[60:63], v12 offset:4608
  v_mfma_f32_32x32x16_bf16 v[96:111], v[28:31], a[4:7], v[96:111]
  buffer_load_dwordx4 a[160:163], v0, s[12:15], s47 offen offset:2048 sc1
  ds_read_b128 v[24:27], v12 offset:5120
  v_mfma_f32_32x32x16_bf16 v[96:111], v[32:35], a[8:11], v[96:111]
  ds_read_b128 v[28:31], v12 offset:5632
  v_mfma_f32_32x32x16_bf16 v[96:111], v[36:39], a[12:15], v[96:111]
  buffer_load_dwordx4 v3, s[68:71], m0 offen offset:3072 sc1 lds
  ds_read_b128 v[32:35], v12 offset:6144
  s_waitcnt lgkmcnt(5)
  v_mfma_f32_32x32x16_bf16 v[96:111], v[40:43], a[16:19], v[96:111]
  v_mul_f32 v64, v80, v80
  v_mul_f32 v65, v81, v81
  v_mul_f32 v66, v82, v82
  ds_read_b128 v[36:39], v12 offset:6656
  v_mfma_f32_32x32x16_bf16 v[96:111], v[44:47], a[20:23], v[96:111]
  s_add_u32 m0, s3, 4096
  s_nop 0
  buffer_load_dwordx4 v3, s[68:71], m0 offen offset:0 sc1 lds
  v_mul_f32 v67, v83, v83
  ds_read_b128 v[40:43], v12 offset:7168
  v_mfma_f32_32x32x16_bf16 v[96:111], v[48:51], a[24:27], v[96:111]
  v_mul_f32 v68, v84, v84
  v_mul_f32 v69, v85, v85
  v_mul_f32 v70, v86, v86
  ds_read_b128 v[44:47], v12 offset:7680
  v_mfma_f32_32x32x16_bf16 v[96:111], v[52:55], a[28:31], v[96:111]
  buffer_load_dwordx4 v3, s[68:71], m0 offen offset:1024 sc1 lds
  ds_read_b128 v[48:51], v12 offset:8192
  s_waitcnt lgkmcnt(5)
  v_mfma_f32_32x32x16_bf16 v[96:111], v[56:59], a[32:35], v[96:111]
  v_mul_f32 v71, v87, v87
  v_fma_f32 v64, v64, v15, v14
  v_fma_f32 v65, v65, v15, v14
  ds_read_b128 v[52:55], v12 offset:8704
  v_mfma_f32_32x32x16_bf16 v[96:111], v[60:63], a[36:39], v[96:111]
  buffer_load_dwordx4 v3, s[68:71], m0 offen offset:2048 sc1 lds
  v_fma_f32 v66, v66, v15, v14
  ds_read_b128 v[56:59], v12 offset:9216
  v_mfma_f32_32x32x16_bf16 v[96:111], v[24:27], a[40:43], v[96:111]
  v_fma_f32 v67, v67, v15, v14
  v_fma_f32 v68, v68, v15, v14
  v_fma_f32 v69, v69, v15, v14
  ds_read_b128 v[60:63], v12 offset:9728
  v_mfma_f32_32x32x16_bf16 v[96:111], v[28:31], a[44:47], v[96:111]
  buffer_load_dwordx4 v3, s[68:71], m0 offen offset:3072 sc1 lds
  ds_read_b128 v[24:27], v12 offset:10240
  s_waitcnt lgkmcnt(5)
  v_mfma_f32_32x32x16_bf16 v[96:111], v[32:35], a[48:51], v[96:111]
  v_fma_f32 v70, v70, v15, v14
  v_fma_f32 v71, v71, v15, v14
  v_mul_f32 v64, v64, v80
  ds_read_b128 v[28:31], v12 offset:10752
  v_mfma_f32_32x32x16_bf16 v[96:111], v[36:39], a[52:55], v[96:111]
  s_add_u32 m0, s3, 8192
  s_nop 0
  buffer_load_dwordx4 v3, s[68:71], m0 offen offset:0 sc1 lds
  v_mul_f32 v65, v65, v81
  ds_read_b128 v[32:35], v12 offset:11264
  v_mfma_f32_32x32x16_bf16 v[96:111], v[40:43], a[56:59], v[96:111]
  v_mul_f32 v66, v66, v82
  v_mul_f32 v67, v67, v83
  v_mul_f32 v68, v68, v84
  ds_read_b128 v[36:39], v12 offset:11776
  v_mfma_f32_32x32x16_bf16 v[96:111], v[44:47], a[60:63], v[96:111]
  buffer_load_dwordx4 v3, s[68:71], m0 offen offset:1024 sc1 lds
  ds_read_b128 v[40:43], v12 offset:12288
  s_waitcnt lgkmcnt(5)
  v_mfma_f32_32x32x16_bf16 v[96:111], v[48:51], a[64:67], v[96:111]
  v_mul_f32 v69, v69, v85
  v_mul_f32 v70, v70, v86
  v_mul_f32 v71, v71, v87
  ds_read_b128 v[44:47], v12 offset:12800
  v_mfma_f32_32x32x16_bf16 v[96:111], v[52:55], a[68:71], v[96:111]
  s_add_u32 s23, s22, 233472
  buffer_load_dwordx4 v[240:243], v3, s[64:67], s23 offen sc1
  v_mul_f32 v80, v80, v88
  ds_read_b128 v[48:51], v12 offset:13312
  v_mfma_f32_32x32x16_bf16 v[96:111], v[56:59], a[72:75], v[96:111]
  v_exp_f32 v64, v64
  v_mul_f32 v81, v81, v89
  ds_read_b128 v[52:55], v12 offset:13824
  v_mfma_f32_32x32x16_bf16 v[96:111], v[60:63], a[76:79], v[96:111]
  s_add_u32 s23, s22, 5120
  buffer_load_dwordx4 v[236:239], v3, s[64:67], s23 offen sc1
  ds_read_b128 v[56:59], v12 offset:14336
  s_waitcnt lgkmcnt(5)
  v_mfma_f32_32x32x16_bf16 v[96:111], v[24:27], a[80:83], v[96:111]
  v_exp_f32 v65, v65
  v_mul_f32 v82, v82, v90
  ds_read_b128 v[60:63], v12 offset:14848
  v_mfma_f32_32x32x16_bf16 v[96:111], v[28:31], a[84:87], v[96:111]
  s_add_u32 s23, s22, 62464
  buffer_load_dwordx4 v[232:235], v3, s[64:67], s23 offen sc1
  v_mul_f32 v83, v83, v91
  ds_read_b128 v[24:27], v12 offset:15360
  v_mfma_f32_32x32x16_bf16 v[96:111], v[32:35], a[88:91], v[96:111]
  v_exp_f32 v66, v66
  v_mul_f32 v84, v84, v92
  ds_read_b128 v[28:31], v12 offset:15872
  v_mfma_f32_32x32x16_bf16 v[96:111], v[36:39], a[92:95], v[96:111]
  s_add_u32 s23, s22, 119808
  buffer_load_dwordx4 v[228:231], v3, s[64:67], s23 offen sc1
  ds_read_b128 v[32:35], v12 offset:16384
  s_waitcnt lgkmcnt(5)
  v_mfma_f32_32x32x16_bf16 v[96:111], v[40:43], a[96:99], v[96:111]
  v_exp_f32 v67, v67
  v_mul_f32 v85, v85, v93
  ds_read_b128 v[36:39], v12 offset:16896
  v_mfma_f32_32x32x16_bf16 v[96:111], v[44:47], a[100:103], v[96:111]
  s_add_u32 s23, s22, 177152
  buffer_load_dwordx4 v[224:227], v3, s[64:67], s23 offen sc1
  v_mul_f32 v86, v86, v94
  ds_read_b128 v[40:43], v12 offset:17408
  v_mfma_f32_32x32x16_bf16 v[96:111], v[48:51], a[104:107], v[96:111]
  v_exp_f32 v68, v68
  v_mul_f32 v87, v87, v95
  ds_read_b128 v[44:47], v12 offset:17920
  v_mfma_f32_32x32x16_bf16 v[96:111], v[52:55], a[108:111], v[96:111]
  s_add_u32 s23, s22, 234496
  buffer_load_dwordx4 v[220:223], v3, s[64:67], s23 offen sc1
  ds_read_b128 v[48:51], v12 offset:18432
  s_waitcnt lgkmcnt(5)
  v_mfma_f32_32x32x16_bf16 v[96:111], v[56:59], a[112:115], v[96:111]
  v_exp_f32 v69, v69
  v_add_f32 v64, 1.0, v64
  ds_read_b128 v[52:55], v12 offset:18944
  v_mfma_f32_32x32x16_bf16 v[96:111], v[60:63], a[116:119], v[96:111]
  s_add_u32 s23, s22, 6144
  buffer_load_dwordx4 v[216:219], v3, s[64:67], s23 offen sc1
  v_add_f32 v65, 1.0, v65
  ds_read_b128 v[56:59], v12 offset:19456
  v_mfma_f32_32x32x16_bf16 v[96:111], v[24:27], a[120:123], v[96:111]
  v_exp_f32 v70, v70
  v_add_f32 v66, 1.0, v66
  ds_read_b128 v[60:63], v12 offset:19968
  v_mfma_f32_32x32x16_bf16 v[96:111], v[28:31], a[124:127], v[96:111]
  s_add_u32 s23, s22, 63488
  buffer_load_dwordx4 v[212:215], v3, s[64:67], s23 offen sc1
  s_waitcnt vmcnt(22)
  s_barrier
  ds_read_b128 v[24:27], v13 offset:0
  s_waitcnt lgkmcnt(5)
  v_mfma_f32_32x32x16_bf16 v[96:111], v[32:35], a[128:131], v[96:111]
  v_exp_f32 v71, v71
  v_add_f32 v67, 1.0, v67
  ds_read_b128 v[28:31], v13 offset:512
  v_mfma_f32_32x32x16_bf16 v[96:111], v[36:39], a[132:135], v[96:111]
  s_add_u32 s23, s22, 120832
  buffer_load_dwordx4 v[208:211], v3, s[64:67], s23 offen sc1
  v_add_f32 v68, 1.0, v68
  ds_read_b128 v[32:35], v13 offset:1024
  v_mfma_f32_32x32x16_bf16 v[96:111], v[40:43], a[136:139], v[96:111]
  v_add_f32 v69, 1.0, v69
  v_add_f32 v70, 1.0, v70
  v_add_f32 v71, 1.0, v71
  ds_read_b128 v[36:39], v13 offset:1536
  v_mfma_f32_32x32x16_bf16 v[96:111], v[44:47], a[140:143], v[96:111]
  s_add_u32 s23, s22, 178176
  buffer_load_dwordx4 v[204:207], v3, s[64:67], s23 offen sc1
  ds_read_b128 v[40:43], v13 offset:2048
  s_waitcnt lgkmcnt(5)
  v_mfma_f32_32x32x16_bf16 v[96:111], v[48:51], a[144:147], v[96:111]
  v_rcp_f32 v64, v64
  ds_read_b128 v[44:47], v13 offset:2560
  v_mfma_f32_32x32x16_bf16 v[96:111], v[52:55], a[148:151], v[96:111]
  s_add_u32 s23, s22, 235520
  buffer_load_dwordx4 v[200:203], v3, s[64:67], s23 offen sc1
  v_mul_f32 v80, v80, v64
  ds_read_b128 v[48:51], v13 offset:3072
  v_mfma_f32_32x32x16_bf16 v[96:111], v[56:59], a[152:155], v[96:111]
  v_rcp_f32 v65, v65
  ds_read_b128 v[52:55], v13 offset:3584
  v_mfma_f32_32x32x16_bf16 v[96:111], v[60:63], a[156:159], v[96:111]
  s_add_u32 s23, s22, 7168
  buffer_load_dwordx4 v[196:199], v3, s[64:67], s23 offen sc1
  v_mfma_f32_32x32x16_bf16 v[96:111], a[164:167], v[16:19], v[96:111]
  ds_read_b128 v[56:59], v13 offset:4096
  s_waitcnt lgkmcnt(5)
  v_mfma_f32_32x32x16_bf16 v[112:127], v[24:27], a[0:3], 0
  v_rcp_f32 v66, v66
  v_mul_f32 v81, v81, v65
  ds_read_b128 v[60:63], v13 offset:4608
  v_mfma_f32_32x32x16_bf16 v[112:127], v[28:31], a[4:7], v[112:127]
  s_add_u32 s23, s22, 64512
  buffer_load_dwordx4 v[192:195], v3, s[64:67], s23 offen sc1
  v_mul_f32 v82, v82, v66
  ds_read_b128 v[24:27], v13 offset:5120
  v_mfma_f32_32x32x16_bf16 v[112:127], v[32:35], a[8:11], v[112:127]
  v_rcp_f32 v67, v67
  v_cvt_pk_bf16_f32 v76, v80, v81
  ds_read_b128 v[28:31], v13 offset:5632
  v_mfma_f32_32x32x16_bf16 v[112:127], v[36:39], a[12:15], v[112:127]
  s_add_u32 s23, s22, 121856
  buffer_load_dwordx4 v[188:191], v3, s[64:67], s23 offen sc1
  ds_read_b128 v[32:35], v13 offset:6144
  s_waitcnt lgkmcnt(5)
  v_mfma_f32_32x32x16_bf16 v[112:127], v[40:43], a[16:19], v[112:127]
  v_rcp_f32 v68, v68
  v_mul_f32 v83, v83, v67
  ds_read_b128 v[36:39], v13 offset:6656
  v_mfma_f32_32x32x16_bf16 v[112:127], v[44:47], a[20:23], v[112:127]
  s_add_u32 s23, s22, 179200
  buffer_load_dwordx4 v[184:187], v3, s[64:67], s23 offen sc1
  v_mul_f32 v84, v84, v68
  ds_read_b128 v[40:43], v13 offset:7168
  v_mfma_f32_32x32x16_bf16 v[112:127], v[48:51], a[24:27], v[112:127]
  v_rcp_f32 v69, v69
  v_cvt_pk_bf16_f32 v77, v82, v83
  ds_read_b128 v[44:47], v13 offset:7680
  v_mfma_f32_32x32x16_bf16 v[112:127], v[52:55], a[28:31], v[112:127]
  s_add_u32 s23, s22, 236544
  buffer_load_dwordx4 v[180:183], v3, s[64:67], s23 offen sc1
  ds_read_b128 v[48:51], v13 offset:8192
  s_waitcnt lgkmcnt(5)
  v_mfma_f32_32x32x16_bf16 v[112:127], v[56:59], a[32:35], v[112:127]
  v_rcp_f32 v70, v70
  v_mul_f32 v85, v85, v69
  ds_read_b128 v[52:55], v13 offset:8704
  v_mfma_f32_32x32x16_bf16 v[112:127], v[60:63], a[36:39], v[112:127]
  s_add_u32 s23, s22, 8192
  buffer_load_dwordx4 v[176:179], v3, s[64:67], s23 offen sc1
  v_mul_f32 v86, v86, v70
  ds_read_b128 v[56:59], v13 offset:9216
  v_mfma_f32_32x32x16_bf16 v[112:127], v[24:27], a[40:43], v[112:127]
  v_rcp_f32 v71, v71
  v_cvt_pk_bf16_f32 v78, v84, v85
  ds_read_b128 v[60:63], v13 offset:9728
  v_mfma_f32_32x32x16_bf16 v[112:127], v[28:31], a[44:47], v[112:127]
  s_add_u32 s23, s22, 65536
  buffer_load_dwordx4 v[172:175], v3, s[64:67], s23 offen sc1
  ds_read_b128 v[24:27], v13 offset:10240
  s_waitcnt lgkmcnt(5)
  v_mfma_f32_32x32x16_bf16 v[112:127], v[32:35], a[48:51], v[112:127]
  v_mul_f32 v87, v87, v71
  v_cvt_pk_bf16_f32 v79, v86, v87
  v_mul_f32 v64, v96, v96
  ds_read_b128 v[28:31], v13 offset:10752
  v_mfma_f32_32x32x16_bf16 v[112:127], v[36:39], a[52:55], v[112:127]
  s_add_u32 s23, s22, 122880
  buffer_load_dwordx4 v[168:171], v3, s[64:67], s23 offen sc1
  v_mul_f32 v65, v97, v97
  ds_read_b128 v[32:35], v13 offset:11264
  v_mfma_f32_32x32x16_bf16 v[112:127], v[40:43], a[56:59], v[112:127]
  buffer_store_dwordx4 v[76:79], v20, s[36:39], s50 offen offset:2048 sc1
  s_add_u32 s50, s50, 4096
  v_mul_f32 v66, v98, v98
  ds_read_b128 v[36:39], v13 offset:11776
  v_mfma_f32_32x32x16_bf16 v[112:127], v[44:47], a[60:63], v[112:127]
  s_add_u32 s23, s22, 180224
  buffer_load_dwordx4 v[164:167], v3, s[64:67], s23 offen sc1
  buffer_load_dword v9, v7, s[8:11], s58 offen sc1
  ds_read_b128 v[40:43], v13 offset:12288
  s_waitcnt lgkmcnt(5)
  v_mfma_f32_32x32x16_bf16 v[112:127], v[48:51], a[64:67], v[112:127]
  v_mul_f32 v67, v99, v99
  v_mul_f32 v68, v100, v100
  v_mul_f32 v69, v101, v101
  ds_read_b128 v[44:47], v13 offset:12800
  v_mfma_f32_32x32x16_bf16 v[112:127], v[52:55], a[68:71], v[112:127]
  s_add_u32 s23, s22, 237568
  buffer_load_dwordx4 v[160:163], v3, s[64:67], s23 offen sc1
  v_mul_f32 v70, v102, v102
  ds_read_b128 v[48:51], v13 offset:13312
  v_mfma_f32_32x32x16_bf16 v[112:127], v[56:59], a[72:75], v[112:127]
  v_mul_f32 v71, v103, v103
  v_fma_f32 v64, v64, v15, v14
  v_fma_f32 v65, v65, v15, v14
  ds_read_b128 v[52:55], v13 offset:13824
  v_mfma_f32_32x32x16_bf16 v[112:127], v[60:63], a[76:79], v[112:127]
  s_add_u32 s23, s22, 9216
  buffer_load_dwordx4 v[156:159], v3, s[64:67], s23 offen sc1
  ds_read_b128 v[56:59], v13 offset:14336
  s_waitcnt lgkmcnt(5)
  v_mfma_f32_32x32x16_bf16 v[112:127], v[24:27], a[80:83], v[112:127]
  v_fma_f32 v66, v66, v15, v14
  v_fma_f32 v67, v67, v15, v14
  v_fma_f32 v68, v68, v15, v14
  ds_read_b128 v[60:63], v13 offset:14848
  v_mfma_f32_32x32x16_bf16 v[112:127], v[28:31], a[84:87], v[112:127]
  s_add_u32 s23, s22, 66560
  buffer_load_dwordx4 v[152:155], v3, s[64:67], s23 offen sc1
  v_fma_f32 v69, v69, v15, v14
  ds_read_b128 v[24:27], v13 offset:15360
  v_mfma_f32_32x32x16_bf16 v[112:127], v[32:35], a[88:91], v[112:127]
  v_fma_f32 v70, v70, v15, v14
  v_fma_f32 v71, v71, v15, v14
  v_mul_f32 v64, v64, v96
  ds_read_b128 v[28:31], v13 offset:15872
  v_mfma_f32_32x32x16_bf16 v[112:127], v[36:39], a[92:95], v[112:127]
  s_add_u32 s23, s22, 123904
  buffer_load_dwordx4 v[148:151], v3, s[64:67], s23 offen sc1
  ds_read_b128 v[32:35], v13 offset:16384
  s_waitcnt lgkmcnt(5)
  v_mfma_f32_32x32x16_bf16 v[112:127], v[40:43], a[96:99], v[112:127]
  v_mul_f32 v65, v65, v97
  v_mul_f32 v66, v66, v98
  v_mul_f32 v67, v67, v99
  ds_read_b128 v[36:39], v13 offset:16896
  v_mfma_f32_32x32x16_bf16 v[112:127], v[44:47], a[100:103], v[112:127]
  s_add_u32 s23, s22, 181248
  buffer_load_dwordx4 v[144:147], v3, s[64:67], s23 offen sc1
  v_mul_f32 v68, v68, v100
  ds_read_b128 v[40:43], v13 offset:17408
  v_mfma_f32_32x32x16_bf16 v[112:127], v[48:51], a[104:107], v[112:127]
  v_mul_f32 v69, v69, v101
  v_mul_f32 v70, v70, v102
  v_mul_f32 v71, v71, v103
  ds_read_b128 v[44:47], v13 offset:17920
  v_mfma_f32_32x32x16_bf16 v[112:127], v[52:55], a[108:111], v[112:127]
  s_add_u32 s23, s22, 238592
  buffer_load_dwordx4 v[140:143], v3, s[64:67], s23 offen sc1
  ds_read_b128 v[48:51], v13 offset:18432
  s_waitcnt lgkmcnt(5)
  v_mfma_f32_32x32x16_bf16 v[112:127], v[56:59], a[112:115], v[112:127]
  v_exp_f32 v64, v64
  v_mul_f32 v96, v96, v104
  ds_read_b128 v[52:55], v13 offset:18944
  v_mfma_f32_32x32x16_bf16 v[112:127], v[60:63], a[116:119], v[112:127]
  s_add_u32 s23, s22, 10240
  buffer_load_dwordx4 v[136:139], v3, s[64:67], s23 offen sc1
  v_mul_f32 v97, v97, v105
  ds_read_b128 v[56:59], v13 offset:19456
  v_mfma_f32_32x32x16_bf16 v[112:127], v[24:27], a[120:123], v[112:127]
  v_exp_f32 v65, v65
  v_mul_f32 v98, v98, v106
  ds_read_b128 v[60:63], v13 offset:19968
  v_mfma_f32_32x32x16_bf16 v[112:127], v[28:31], a[124:127], v[112:127]
  s_add_u32 s23, s22, 67584
  buffer_load_dwordx4 v[132:135], v3, s[64:67], s23 offen sc1
  s_waitcnt vmcnt(30)
  s_barrier
  ds_read_b128 v[24:27], v10 offset:0
  s_waitcnt lgkmcnt(5)
  v_mfma_f32_32x32x16_bf16 v[112:127], v[32:35], a[128:131], v[112:127]
  v_exp_f32 v66, v66
  v_mul_f32 v99, v99, v107
  ds_read_b128 v[28:31], v10 offset:512
  v_mfma_f32_32x32x16_bf16 v[112:127], v[36:39], a[132:135], v[112:127]
  s_add_u32 s23, s22, 124928
  buffer_load_dwordx4 v[128:131], v3, s[64:67], s23 offen sc1
  v_mul_f32 v100, v100, v108
  ds_read_b128 v[32:35], v10 offset:1024
  v_mfma_f32_32x32x16_bf16 v[112:127], v[40:43], a[136:139], v[112:127]
  v_exp_f32 v67, v67
  v_mul_f32 v101, v101, v109
  ds_read_b128 v[36:39], v10 offset:1536
  v_mfma_f32_32x32x16_bf16 v[112:127], v[44:47], a[140:143], v[112:127]
  v_exp_f32 v68, v68
  ds_read_b128 v[40:43], v10 offset:2048
  s_waitcnt lgkmcnt(5)
  v_mfma_f32_32x32x16_bf16 v[112:127], v[48:51], a[144:147], v[112:127]
  v_exp_f32 v69, v69
  v_mul_f32 v102, v102, v110
  ds_read_b128 v[44:47], v10 offset:2560
  v_mfma_f32_32x32x16_bf16 v[112:127], v[52:55], a[148:151], v[112:127]
  v_exp_f32 v70, v70
  v_mul_f32 v103, v103, v111
  s_waitcnt vmcnt(9)
  v_cmp_ne_u32 vcc, s93, v9
  s_mov_b32 s92, 0
  s_nop 3
  s_cbranch_vccz M_f4e_ok
M_f4e:
  buffer_load_dword v9, v7, s[8:11], s58 offen sc1
  s_add_u32 s92, s92, 1
  s_waitcnt vmcnt(0)
  s_cmp_gt_u32 s92, 400000
  s_cbranch_scc1 M_f4e_ok
  v_cmp_ne_u32 vcc, s93, v9
  s_nop 4
  s_cbranch_vccnz M_f4e
M_f4e_ok:
  ds_read_b128 v[48:51], v10 offset:3072
  v_mfma_f32_32x32x16_bf16 v[112:127], v[56:59], a[152:155], v[112:127]
  buffer_store_dword v1, v8, s[8:11], s56 offen sc0 sc1
  ds_read_b128 v[52:55], v10 offset:3584
  v_mfma_f32_32x32x16_bf16 v[112:127], v[60:63], a[156:159], v[112:127]
  v_exp_f32 v71, v71
  v_mfma_f32_32x32x16_bf16 v[112:127], a[168:171], v[16:19], v[112:127]
  ds_read_b128 v[56:59], v10 offset:4096
  s_waitcnt lgkmcnt(5)
  v_mfma_f32_32x32x16_bf16 v[80:95], v[24:27], a[0:3], 0
  v_add_f32 v64, 1.0, v64
  v_add_f32 v65, 1.0, v65
  v_add_f32 v66, 1.0, v66
  ds_read_b128 v[60:63], v10 offset:4608
  v_mfma_f32_32x32x16_bf16 v[80:95], v[28:31], a[4:7], v[80:95]
  s_add_u32 s55, s96, 1
  s_and_b32 s55, s55, 3
  s_mul_i32 s55, s55, 57344
  s_add_u32 s55, s55, s57
  buffer_load_dwordx4 a[0:3], v3, s[36:39], s55 offen offset:0 sc1
  v_add_f32 v67, 1.0, v67
  ds_read_b128 v[24:27], v10 offset:5120
  v_mfma_f32_32x32x16_bf16 v[80:95], v[32:35], a[8:11], v[80:95]
  v_add_f32 v68, 1.0, v68
  v_add_f32 v69, 1.0, v69
  v_add_f32 v70, 1.0, v70
  ds_read_b128 v[28:31], v10 offset:5632
  v_mfma_f32_32x32x16_bf16 v[80:95], v[36:39], a[12:15], v[80:95]
  buffer_load_dwordx4 a[4:7], v3, s[36:39], s55 offen offset:1024 sc1
  ds_read_b128 v[32:35], v10 offset:6144
  s_waitcnt lgkmcnt(5)
  v_mfma_f32_32x32x16_bf16 v[80:95], v[40:43], a[16:19], v[80:95]
  v_add_f32 v71, 1.0, v71
  v_rcp_f32 v64, v64
  ds_read_b128 v[36:39], v10 offset:6656
  v_mfma_f32_32x32x16_bf16 v[80:95], v[44:47], a[20:23], v[80:95]
  buffer_load_dwordx4 a[8:11], v3, s[36:39], s55 offen offset:2048 sc1
  v_mul_f32 v96, v96, v64
  ds_read_b128 v[40:43], v10 offset:7168
  v_mfma_f32_32x32x16_bf16 v[80:95], v[48:51], a[24:27], v[80:95]
  v_rcp_f32 v65, v65
  ds_read_b128 v[44:47], v10 offset:7680
  v_mfma_f32_32x32x16_bf16 v[80:95], v[52:55], a[28:31], v[80:95]
  buffer_load_dwordx4 a[12:15], v3, s[36:39], s55 offen offset:3072 sc1
  ds_read_b128 v[48:51], v10 offset:8192
  s_waitcnt lgkmcnt(5)
  v_mfma_f32_32x32x16_bf16 v[80:95], v[56:59], a[32:35], v[80:95]
  v_rcp_f32 v66, v66
  v_mul_f32 v97, v97, v65
  ds_read_b128 v[52:55], v10 offset:8704
  v_mfma_f32_32x32x16_bf16 v[80:95], v[60:63], a[36:39], v[80:95]
  s_add_u32 s55, s55, 4096
  buffer_load_dwordx4 a[16:19], v3, s[36:39], s55 offen offset:0 sc1
  v_mul_f32 v98, v98, v66
  ds_read_b128 v[56:59], v10 offset:9216
  v_mfma_f32_32x32x16_bf16 v[80:95], v[24:27], a[40:43], v[80:95]
  v_rcp_f32 v67, v67
  v_cvt_pk_bf16_f32 v72, v96, v97
  ds_read_b128 v[60:63], v10 offset:9728
  v_mfma_f32_32x32x16_bf16 v[80:95], v[28:31], a[44:47], v[80:95]
  buffer_load_dwordx4 a[20:23], v3, s[36:39], s55 offen offset:1024 sc1
  ds_read_b128 v[24:27], v10 offset:10240
  s_waitcnt lgkmcnt(5)
  v_mfma_f32_32x32x16_bf16 v[80:95], v[32:35], a[48:51], v[80:95]
  v_rcp_f32 v68, v68
  v_mul_f32 v99, v99, v67
  ds_read_b128 v[28:31], v10 offset:10752
  v_mfma_f32_32x32x16_bf16 v[80:95], v[36:39], a[52:55], v[80:95]
  s_add_u32 s55, s96, 2
  s_and_b32 s55, s55, 3
  s_mul_i32 s55, s55, 57344
  s_add_u32 s55, s55, s57
  buffer_load_dwordx4 a[24:27], v3, s[36:39], s55 offen offset:0 sc1
  v_mul_f32 v100, v100, v68
  ds_read_b128 v[32:35], v10 offset:11264
  v_mfma_f32_32x32x16_bf16 v[80:95], v[40:43], a[56:59], v[80:95]
  v_rcp_f32 v69, v69
  v_cvt_pk_bf16_f32 v73, v98, v99
  ds_read_b128 v[36:39], v10 offset:11776
  v_mfma_f32_32x32x16_bf16 v[80:95], v[44:47], a[60:63], v[80:95]
  buffer_load_dwordx4 a[28:31], v3, s[36:39], s55 offen offset:1024 sc1
  ds_read_b128 v[40:43], v10 offset:12288
  s_waitcnt lgkmcnt(5)
  v_mfma_f32_32x32x16_bf16 v[80:95], v[48:51], a[64:67], v[80:95]
  v_rcp_f32 v70, v70
  v_mul_f32 v101, v101, v69
  ds_read_b128 v[44:47], v10 offset:12800
  v_mfma_f32_32x32x16_bf16 v[80:95], v[52:55], a[68:71], v[80:95]
  buffer_load_dwordx4 a[32:35], v3, s[36:39], s55 offen offset:2048 sc1
  v_mul_f32 v102, v102, v70
  ds_read_b128 v[48:51], v10 offset:13312
  v_mfma_f32_32x32x16_bf16 v[80:95], v[56:59], a[72:75], v[80:95]
  v_rcp_f32 v71, v71
  v_cvt_pk_bf16_f32 v74, v100, v101
  ds_read_b128 v[52:55], v10 offset:13824
  v_mfma_f32_32x32x16_bf16 v[80:95], v[60:63], a[76:79], v[80:95]
  buffer_load_dwordx4 a[36:39], v3, s[36:39], s55 offen offset:3072 sc1
  ds_read_b128 v[56:59], v10 offset:14336
  s_waitcnt lgkmcnt(5)
  v_mfma_f32_32x32x16_bf16 v[80:95], v[24:27], a[80:83], v[80:95]
  v_mul_f32 v103, v103, v71
  v_cvt_pk_bf16_f32 v75, v102, v103
  v_mul_f32 v64, v112, v112
  ds_read_b128 v[60:63], v10 offset:14848
  v_mfma_f32_32x32x16_bf16 v[80:95], v[28:31], a[84:87], v[80:95]
  s_add_u32 s55, s55, 4096
  buffer_load_dwordx4 a[40:43], v3, s[36:39], s55 offen offset:0 sc1
  v_mul_f32 v65, v113, v113
  ds_read_b128 v[24:27], v10 offset:15360
  v_mfma_f32_32x32x16_bf16 v[80:95], v[32:35], a[88:91], v[80:95]
  buffer_store_dwordx4 v[72:75], v20, s[36:39], s50 offen offset:0 sc1
  v_mul_f32 v66, v114, v114
  ds_read_b128 v[28:31], v10 offset:15872
  v_mfma_f32_32x32x16_bf16 v[80:95], v[36:39], a[92:95], v[80:95]
  buffer_load_dwordx4 a[44:47], v3, s[36:39], s55 offen offset:1024 sc1
  ds_read_b128 v[32:35], v10 offset:16384
  s_waitcnt lgkmcnt(5)
  v_mfma_f32_32x32x16_bf16 v[80:95], v[40:43], a[96:99], v[80:95]
  v_mul_f32 v67, v115, v115
  v_mul_f32 v68, v116, v116
  v_mul_f32 v69, v117, v117
  ds_read_b128 v[36:39], v10 offset:16896
  v_mfma_f32_32x32x16_bf16 v[80:95], v[44:47], a[100:103], v[80:95]
  s_add_u32 s55, s96, 3
  s_and_b32 s55, s55, 3
  s_mul_i32 s55, s55, 57344
  s_add_u32 s55, s55, s57
  buffer_load_dwordx4 a[48:51], v3, s[36:39], s55 offen offset:0 sc1
  v_mul_f32 v70, v118, v118
  ds_read_b128 v[40:43], v10 offset:17408
  v_mfma_f32_32x32x16_bf16 v[80:95], v[48:51], a[104:107], v[80:95]
  v_mul_f32 v71, v119, v119
  v_fma_f32 v64, v64, v15, v14
  v_fma_f32 v65, v65, v15, v14
  ds_read_b128 v[44:47], v10 offset:17920
  v_mfma_f32_32x32x16_bf16 v[80:95], v[52:55], a[108:111], v[80:95]
  buffer_load_dwordx4 a[52:55], v3, s[36:39], s55 offen offset:1024 sc1
  ds_read_b128 v[48:51], v10 offset:18432
  s_waitcnt lgkmcnt(5)
  v_mfma_f32_32x32x16_bf16 v[80:95], v[56:59], a[112:115], v[80:95]
  v_fma_f32 v66, v66, v15, v14
  v_fma_f32 v67, v67, v15, v14
  v_fma_f32 v68, v68, v15, v14
  ds_read_b128 v[52:55], v10 offset:18944
  v_mfma_f32_32x32x16_bf16 v[80:95], v[60:63], a[116:119], v[80:95]
  buffer_load_dwordx4 a[56:59], v3, s[36:39], s55 offen offset:2048 sc1
  v_fma_f32 v69, v69, v15, v14
  ds_read_b128 v[56:59], v10 offset:19456
  v_mfma_f32_32x32x16_bf16 v[80:95], v[24:27], a[120:123], v[80:95]
  v_fma_f32 v70, v70, v15, v14
  v_fma_f32 v71, v71, v15, v14
  v_mul_f32 v64, v64, v112
  ds_read_b128 v[60:63], v10 offset:19968
  v_mfma_f32_32x32x16_bf16 v[80:95], v[28:31], a[124:127], v[80:95]
  buffer_load_dwordx4 a[60:63], v3, s[36:39], s55 offen offset:3072 sc1
  s_waitcnt lgkmcnt(4)
  v_mfma_f32_32x32x16_bf16 v[80:95], v[32:35], a[128:131], v[80:95]
  v_mul_f32 v65, v65, v113
  v_mul_f32 v66, v66, v114
  v_mul_f32 v67, v67, v115
  v_mfma_f32_32x32x16_bf16 v[80:95], v[36:39], a[132:135], v[80:95]
  s_add_u32 s55, s55, 4096
  buffer_load_dwordx4 a[64:67], v3, s[36:39], s55 offen offset:0 sc1
  v_mul_f32 v68, v68, v116
  v_mfma_f32_32x32x16_bf16 v[80:95], v[40:43], a[136:139], v[80:95]
  v_mul_f32 v69, v69, v117
  v_mul_f32 v70, v70, v118
  v_mul_f32 v71, v71, v119
  v_mfma_f32_32x32x16_bf16 v[80:95], v[44:47], a[140:143], v[80:95]
  buffer_load_dwordx4 a[68:71], v3, s[36:39], s55 offen offset:1024 sc1
  s_waitcnt lgkmcnt(0)
  v_mfma_f32_32x32x16_bf16 v[80:95], v[48:51], a[144:147], v[80:95]
  v_exp_f32 v64, v64
  v_mul_f32 v112, v112, v120
  v_mfma_f32_32x32x16_bf16 v[80:95], v[52:55], a[148:151], v[80:95]
  s_add_u32 s55, s96, 0
  s_and_b32 s55, s55, 3
  s_mul_i32 s55, s55, 57344
  s_add_u32 s55, s55, s57
  buffer_load_dwordx4 a[72:75], v3, s[36:39], s55 offen offset:0 sc1
  v_mul_f32 v113, v113, v121
  v_mfma_f32_32x32x16_bf16 v[80:95], v[56:59], a[152:155], v[80:95]
  v_exp_f32 v65, v65
  v_mul_f32 v114, v114, v122
  v_mfma_f32_32x32x16_bf16 v[80:95], v[60:63], a[156:159], v[80:95]
  buffer_load_dwordx4 a[76:79], v3, s[36:39], s55 offen offset:1024 sc1
  v_mfma_f32_32x32x16_bf16 v[80:95], a[160:163], v[16:19], v[80:95]
  v_exp_f32 v66, v66
  v_exp_f32 v67, v67
  v_mul_f32 v115, v115, v123
  v_exp_f32 v68, v68
  v_mul_f32 v116, v116, v124
  v_exp_f32 v69, v69
  v_mul_f32 v117, v117, v125
  v_exp_f32 v70, v70
  v_mul_f32 v118, v118, v126
  v_exp_f32 v71, v71
  v_mul_f32 v119, v119, v127
  v_add_f32 v64, 1.0, v64
  v_add_f32 v65, 1.0, v65
  v_add_f32 v66, 1.0, v66
  v_add_f32 v67, 1.0, v67
  v_add_f32 v68, 1.0, v68
  v_add_f32 v69, 1.0, v69
  v_add_f32 v70, 1.0, v70
  v_add_f32 v71, 1.0, v71
  v_rcp_f32 v64, v64
  v_rcp_f32 v65, v65
  v_mul_f32 v112, v112, v64
  v_rcp_f32 v66, v66
  v_mul_f32 v113, v113, v65
  v_rcp_f32 v67, v67
  v_mul_f32 v114, v114, v66
  v_rcp_f32 v68, v68
  v_mul_f32 v115, v115, v67
  v_rcp_f32 v69, v69
  v_mul_f32 v116, v116, v68
  v_rcp_f32 v70, v70
  v_mul_f32 v117, v117, v69
  v_rcp_f32 v71, v71
  v_mul_f32 v118, v118, v70
  v_cvt_pk_bf16_f32 v76, v112, v113
  v_mul_f32 v119, v119, v71
  v_cvt_pk_bf16_f32 v77, v114, v115
  v_cvt_pk_bf16_f32 v78, v116, v117
  v_cvt_pk_bf16_f32 v79, v118, v119
  buffer_store_dwordx4 v[76:79], v20, s[36:39], s50 offen offset:2048 sc1
  s_add_u32 s50, s50, 4096
  v_pk_mul_f32 v[64:65], v[80:81], v[80:81]
  v_pk_mul_f32 v[66:67], v[82:83], v[82:83]
  v_pk_mul_f32 v[68:69], v[84:85], v[84:85]
  v_pk_mul_f32 v[70:71], v[86:87], v[86:87]
  v_pk_fma_f32 v[64:65], v[64:65], v[14:15], v[14:15] op_sel:[0,1,0] op_sel_hi:[1,1,0]
  v_pk_fma_f32 v[66:67], v[66:67], v[14:15], v[14:15] op_sel:[0,1,0] op_sel_hi:[1,1,0]
  v_pk_fma_f32 v[68:69], v[68:69], v[14:15], v[14:15] op_sel:[0,1,0] op_sel_hi:[1,1,0]
  v_pk_fma_f32 v[70:71], v[70:71], v[14:15], v[14:15] op_sel:[0,1,0] op_sel_hi:[1,1,0]
  v_pk_mul_f32 v[64:65], v[64:65], v[80:81]
  v_pk_mul_f32 v[66:67], v[66:67], v[82:83]
  v_pk_mul_f32 v[68:69], v[68:69], v[84:85]
  v_pk_mul_f32 v[70:71], v[70:71], v[86:87]
  v_exp_f32 v64, v64
  v_exp_f32 v65, v65
  v_exp_f32 v66, v66
  v_exp_f32 v67, v67
  v_exp_f32 v68, v68
  v_exp_f32 v69, v69
  v_exp_f32 v70, v70
  v_exp_f32 v71, v71
  v_pk_mul_f32 v[80:81], v[80:81], v[88:89]
  v_pk_mul_f32 v[82:83], v[82:83], v[90:91]
  v_pk_mul_f32 v[84:85], v[84:85], v[92:93]
  v_pk_mul_f32 v[86:87], v[86:87], v[94:95]
  v_pk_add_f32 v[64:65], v[64:65], 1.0 op_sel_hi:[1,0]
  v_pk_add_f32 v[66:67], v[66:67], 1.0 op_sel_hi:[1,0]
  v_pk_add_f32 v[68:69], v[68:69], 1.0 op_sel_hi:[1,0]
  v_pk_add_f32 v[70:71], v[70:71], 1.0 op_sel_hi:[1,0]
  v_rcp_f32 v64, v64
  v_rcp_f32 v65, v65
  v_rcp_f32 v66, v66
  v_rcp_f32 v67, v67
  v_rcp_f32 v68, v68
  v_rcp_f32 v69, v69
  v_rcp_f32 v70, v70
  v_rcp_f32 v71, v71
  v_pk_mul_f32 v[80:81], v[80:81], v[64:65]
  v_pk_mul_f32 v[82:83], v[82:83], v[66:67]
  v_pk_mul_f32 v[84:85], v[84:85], v[68:69]
  v_pk_mul_f32 v[86:87], v[86:87], v[70:71]
  v_cvt_pk_bf16_f32 v72, v80, v81
  v_cvt_pk_bf16_f32 v73, v82, v83
  v_cvt_pk_bf16_f32 v74, v84, v85
  v_cvt_pk_bf16_f32 v75, v86, v87
  buffer_store_dwordx4 v[72:75], v20, s[36:39], s50 offen offset:0 sc1
  s_mov_b32 s12, s6
  s_mov_b32 s13, s7
  s_mov_b32 s14, 2621440
  s_mov_b32 s15, 0x20000
  s_mul_i32 s47, s95, 15360
  s_add_u32 s47, s47, 40960
  v_add_u32 v6, s47, v3
  s_add_u32 s47, s95, 1
  s_and_b32 s47, s47, 3
  s_mul_i32 s47, s47, 15360
  s_add_u32 s47, s47, 51200
  v_add_u32 v10, s47, v3
  s_add_u32 s47, s95, 2
  s_and_b32 s47, s47, 3
  s_mul_i32 s47, s47, 15360
  s_add_u32 s47, s47, 46080
  v_add_u32 v11, s47, v3
  s_add_u32 s47, s95, 3
  s_and_b32 s47, s47, 3
  s_mul_i32 s47, s47, 15360
  s_add_u32 s47, s47, 40960
  v_add_u32 v12, s47, v3
  v_and_b32 v13, 15, v2
  v_lshrrev_b32 v14, 4, v2
  v_lshlrev_b32 v15, 4, v13
  v_lshl_add_u32 v15, v4, 9, v15
  v_and_b32 v16, 1, v14
  v_lshl_add_u32 v15, v16, 3, v15
  s_lshl_b32 s48, s100, 1
  s_lshr_b32 s49, s96, 1
  s_add_u32 s48, s48, s49
  s_mul_i32 s48, s48, 40960
  s_mul_i32 s49, s101, 5120
  s_add_u32 s48, s48, s49
  s_and_b32 s49, s96, 1
  s_lshl_b32 s49, s49, 8
  s_add_u32 s48, s48, s49
  s_add_u32 s49, s48, 4096
  v_lshlrev_b32 v16, 2, v13
  s_lshl_b32 s50, s95, 13
  s_lshl_b32 s51, s100, 8
  s_add_u32 s50, s50, s51
  s_lshl_b32 s51, s96, 6
  s_add_u32 s50, s50, s51
  v_mul_u32_u24 v17, 160, v13
  v_lshl_add_u32 v17, v14, 3, v17
  s_mul_i32 s51, s95, 2560
  s_add_u32 s51, s51, 102400
  v_add_u32 v17, s51, v17
  v_add_u32 v18, s51, v3
  s_mov_b32 s52, 6554
  v_add_u32 v13, 0, v2
  v_mul_u32_u24 v14, s52, v13
  v_lshrrev_b32 v14, 16, v14
  v_mul_u32_u24 v14, 1120, v14
  v_lshl_add_u32 v19, v13, 4, v14
  v_add_u32 v13, 64, v2
  v_mul_u32_u24 v14, s52, v13
  v_lshrrev_b32 v14, 16, v14
  v_mul_u32_u24 v14, 1120, v14
  v_lshl_add_u32 v20, v13, 4, v14
  v_add_u32 v13, 128, v2
  v_mul_u32_u24 v14, s52, v13
  v_lshrrev_b32 v14, 16, v14
  v_mul_u32_u24 v14, 1120, v14
  v_lshl_add_u32 v21, v13, 4, v14
  s_lshl_b32 s52, s100, 2
  s_add_u32 s52, s52, s96
  s_mul_i32 s52, s52, 20480
  s_mul_i32 s53, s101, 160
  s_add_u32 s52, s52, s53
  s_mov_b32 s54, 0xffff0000
  s_or_b32 s40, s2, s95
  s_cmp_lg_u32 s40, 0
  s_cbranch_scc1 M_noclr
  s_load_dwordx2 s[40:41], s[0:1], 72
  s_mov_b64 exec, 1
  v_mov_b32 v13, 0
  s_waitcnt lgkmcnt(0)
  global_store_dword v13, v13, s[40:41] sc0 sc1
  s_mov_b64 exec, -1
M_noclr:
  s_add_u32 s62, s63, 98304
  s_buffer_load_dwordx8 s[40:47], s[8:11], s62 glc
  s_waitcnt vmcnt(22)
  v_mfma_f32_16x16x32_bf16 v[24:27], a[172:175], a[0:3], 0
  v_mfma_f32_16x16x32_bf16 v[28:31], a[176:179], a[0:3], 0
  v_mfma_f32_16x16x32_bf16 v[32:35], a[180:183], a[0:3], 0
  v_mfma_f32_16x16x32_bf16 v[36:39], a[184:187], a[0:3], 0
  v_mfma_f32_16x16x32_bf16 v[40:43], a[188:191], a[0:3], 0
  s_waitcnt vmcnt(21)
  v_mfma_f32_16x16x32_bf16 v[24:27], a[192:195], a[4:7], v[24:27]
  v_mfma_f32_16x16x32_bf16 v[28:31], a[196:199], a[4:7], v[28:31]
  v_mfma_f32_16x16x32_bf16 v[32:35], a[200:203], a[4:7], v[32:35]
  v_mfma_f32_16x16x32_bf16 v[36:39], a[204:207], a[4:7], v[36:39]
  v_mfma_f32_16x16x32_bf16 v[40:43], a[208:211], a[4:7], v[40:43]
  s_waitcnt vmcnt(20)
  v_mfma_f32_16x16x32_bf16 v[24:27], a[212:215], a[8:11], v[24:27]
  v_mfma_f32_16x16x32_bf16 v[28:31], a[216:219], a[8:11], v[28:31]
  v_mfma_f32_16x16x32_bf16 v[32:35], a[220:223], a[8:11], v[32:35]
  v_mfma_f32_16x16x32_bf16 v[36:39], a[224:227], a[8:11], v[36:39]
  v_mfma_f32_16x16x32_bf16 v[40:43], a[228:231], a[8:11], v[40:43]
  s_waitcnt vmcnt(19)
  v_mfma_f32_16x16x32_bf16 v[24:27], a[232:235], a[12:15], v[24:27]
  v_mfma_f32_16x16x32_bf16 v[28:31], a[236:239], a[12:15], v[28:31]
  v_mfma_f32_16x16x32_bf16 v[32:35], a[240:243], a[12:15], v[32:35]
  v_mfma_f32_16x16x32_bf16 v[36:39], a[244:247], a[12:15], v[36:39]
  v_mfma_f32_16x16x32_bf16 v[40:43], a[248:251], a[12:15], v[40:43]
  s_waitcnt vmcnt(18)
  v_mfma_f32_16x16x32_bf16 v[24:27], a[252:255], a[16:19], v[24:27]
  v_mfma_f32_16x16x32_bf16 v[28:31], v[252:255], a[16:19], v[28:31]
  v_mfma_f32_16x16x32_bf16 v[32:35], v[248:251], a[16:19], v[32:35]
  v_mfma_f32_16x16x32_bf16 v[36:39], v[244:247], a[16:19], v[36:39]
  v_mfma_f32_16x16x32_bf16 v[40:43], v[240:243], a[16:19], v[40:43]
  s_waitcnt vmcnt(0)
  buffer_store_dword v1, v8, s[8:11], s59 offen sc0 sc1
  v_mfma_f32_16x16x32_bf16 v[24:27], v[236:239], a[20:23], v[24:27]
  buffer_load_dwordx4 a[80:83], v3, s[36:39], s55 offen offset:2048 sc1
  v_mfma_f32_16x16x32_bf16 v[28:31], v[232:235], a[20:23], v[28:31]
  v_mfma_f32_16x16x32_bf16 v[32:35], v[228:231], a[20:23], v[32:35]
  buffer_load_dwordx4 a[84:87], v3, s[36:39], s55 offen offset:3072 sc1
  v_mfma_f32_16x16x32_bf16 v[36:39], v[224:227], a[20:23], v[36:39]
  v_mfma_f32_16x16x32_bf16 v[40:43], v[220:223], a[20:23], v[40:43]
  v_mfma_f32_16x16x32_bf16 v[44:47], a[172:175], a[24:27], 0
  s_add_u32 s55, s55, 4096
  buffer_load_dwordx4 a[88:91], v3, s[36:39], s55 offen offset:0 sc1
  v_mfma_f32_16x16x32_bf16 v[48:51], a[176:179], a[24:27], 0
  v_mfma_f32_16x16x32_bf16 v[52:55], a[180:183], a[24:27], 0
  buffer_load_dwordx4 a[92:95], v3, s[36:39], s55 offen offset:1024 sc1
  v_mfma_f32_16x16x32_bf16 v[56:59], a[184:187], a[24:27], 0
  v_mfma_f32_16x16x32_bf16 v[60:63], a[188:191], a[24:27], 0
  s_waitcnt lgkmcnt(0)
  s_and_b64 s[60:61], s[40:41], s[42:43]
  s_or_b64 s[40:41], s[40:41], s[42:43]
  s_and_b64 s[42:43], s[44:45], s[46:47]
  s_or_b64 s[44:45], s[44:45], s[46:47]
  s_and_b64 s[60:61], s[60:61], s[42:43]
  s_or_b64 s[40:41], s[40:41], s[44:45]
  s_and_b32 s60, s60, s61
  s_or_b32 s61, s40, s41
  s_mov_b32 s92, s93
  s_cmp_eq_u64 s[60:61], s[92:93]
  s_cbranch_scc1 M_f4m_ok
  s_mov_b32 s92, 0
M_f4m:
  buffer_load_dword v9, v7, s[8:11], s56 offen sc1
  s_add_u32 s92, s92, 1
  s_waitcnt vmcnt(0)
  s_cmp_gt_u32 s92, 400000
  s_cbranch_scc1 M_f4m_ok
  v_cmp_ne_u32 vcc, s93, v9
  s_nop 4
  s_cbranch_vccnz M_f4m
M_f4m_ok:
  v_mfma_f32_16x16x32_bf16 v[44:47], a[192:195], a[28:31], v[44:47]
  s_add_u32 s55, s96, 1
  s_and_b32 s55, s55, 3
  s_mul_i32 s55, s55, 57344
  s_add_u32 s55, s55, s57
  s_add_u32 s55, s55, 6144
  buffer_load_dwordx4 a[0:3], v3, s[36:39], s55 offen offset:0 sc1
  v_mfma_f32_16x16x32_bf16 v[48:51], a[196:199], a[28:31], v[48:51]
  v_mfma_f32_16x16x32_bf16 v[52:55], a[200:203], a[28:31], v[52:55]
  buffer_load_dwordx4 a[4:7], v3, s[36:39], s55 offen offset:1024 sc1
  v_mfma_f32_16x16x32_bf16 v[56:59], a[204:207], a[28:31], v[56:59]
  v_mfma_f32_16x16x32_bf16 v[60:63], a[208:211], a[28:31], v[60:63]
  v_mfma_f32_16x16x32_bf16 v[44:47], a[212:215], a[32:35], v[44:47]
  s_add_u32 s55, s96, 2
  s_and_b32 s55, s55, 3
  s_mul_i32 s55, s55, 57344
  s_add_u32 s55, s55, s57
  s_add_u32 s55, s55, 6144
  buffer_load_dwordx4 a[8:11], v3, s[36:39], s55 offen offset:0 sc1
  v_mfma_f32_16x16x32_bf16 v[48:51], a[216:219], a[32:35], v[48:51]
  v_mfma_f32_16x16x32_bf16 v[52:55], a[220:223], a[32:35], v[52:55]
  buffer_load_dwordx4 a[12:15], v3, s[36:39], s55 offen offset:1024 sc1
  v_mfma_f32_16x16x32_bf16 v[56:59], a[224:227], a[32:35], v[56:59]
  v_mfma_f32_16x16x32_bf16 v[60:63], a[228:231], a[32:35], v[60:63]
  v_mfma_f32_16x16x32_bf16 v[44:47], a[232:235], a[36:39], v[44:47]
  s_add_u32 s55, s96, 3
  s_and_b32 s55, s55, 3
  s_mul_i32 s55, s55, 57344
  s_add_u32 s55, s55, s57
  s_add_u32 s55, s55, 6144
  buffer_load_dwordx4 a[16:19], v3, s[36:39], s55 offen offset:0 sc1
  v_mfma_f32_16x16x32_bf16 v[48:51], a[236:239], a[36:39], v[48:51]
  v_mfma_f32_16x16x32_bf16 v[52:55], a[240:243], a[36:39], v[52:55]
  buffer_load_dwordx4 a[20:23], v3, s[36:39], s55 offen offset:1024 sc1
  v_mfma_f32_16x16x32_bf16 v[56:59], a[244:247], a[36:39], v[56:59]
  v_mfma_f32_16x16x32_bf16 v[60:63], a[248:251], a[36:39], v[60:63]
  v_mfma_f32_16x16x32_bf16 v[44:47], a[252:255], a[40:43], v[44:47]
  s_add_u32 s55, s96, 0
  s_and_b32 s55, s55, 3
  s_mul_i32 s55, s55, 57344
  s_add_u32 s55, s55, s57
  s_add_u32 s55, s55, 6144
  buffer_load_dwordx4 a[24:27], v3, s[36:39], s55 offen offset:0 sc1
  v_mfma_f32_16x16x32_bf16 v[48:51], v[252:255], a[40:43], v[48:51]
  v_mfma_f32_16x16x32_bf16 v[52:55], v[248:251], a[40:43], v[52:55]
  buffer_load_dwordx4 a[28:31], v3, s[36:39], s55 offen offset:1024 sc1
  v_mfma_f32_16x16x32_bf16 v[56:59], v[244:247], a[40:43], v[56:59]
  v_mfma_f32_16x16x32_bf16 v[60:63], v[240:243], a[40:43], v[60:63]
  v_mfma_f32_16x16x32_bf16 v[44:47], v[236:239], a[44:47], v[44:47]
  s_add_u32 s23, s22, 182272
  buffer_load_dwordx4 a[96:99], v3, s[64:67], s23 offen sc1
  v_mfma_f32_16x16x32_bf16 v[48:51], v[232:235], a[44:47], v[48:51]
  v_mfma_f32_16x16x32_bf16 v[52:55], v[228:231], a[44:47], v[52:55]
  s_add_u32 s23, s22, 239616
  buffer_load_dwordx4 a[100:103], v3, s[64:67], s23 offen sc1
  v_mfma_f32_16x16x32_bf16 v[56:59], v[224:227], a[44:47], v[56:59]
  v_mfma_f32_16x16x32_bf16 v[60:63], v[220:223], a[44:47], v[60:63]
  v_mfma_f32_16x16x32_bf16 v[64:67], a[172:175], a[48:51], 0
  s_add_u32 s23, s22, 11264
  buffer_load_dwordx4 a[104:107], v3, s[64:67], s23 offen sc1
  v_mfma_f32_16x16x32_bf16 v[68:71], a[176:179], a[48:51], 0
  v_mfma_f32_16x16x32_bf16 v[72:75], a[180:183], a[48:51], 0
  s_add_u32 s23, s22, 68608
  buffer_load_dwordx4 a[108:111], v3, s[64:67], s23 offen sc1
  v_mfma_f32_16x16x32_bf16 v[76:79], a[184:187], a[48:51], 0
  v_mfma_f32_16x16x32_bf16 v[80:83], a[188:191], a[48:51], 0
  v_mfma_f32_16x16x32_bf16 v[64:67], a[192:195], a[52:55], v[64:67]
  s_add_u32 s23, s22, 125952
  buffer_load_dwordx4 a[112:115], v3, s[64:67], s23 offen sc1
  v_mfma_f32_16x16x32_bf16 v[68:71], a[196:199], a[52:55], v[68:71]
  v_mfma_f32_16x16x32_bf16 v[72:75], a[200:203], a[52:55], v[72:75]
  s_add_u32 s23, s22, 183296
  buffer_load_dwordx4 a[116:119], v3, s[64:67], s23 offen sc1
  v_mfma_f32_16x16x32_bf16 v[76:79], a[204:207], a[52:55], v[76:79]
  v_mfma_f32_16x16x32_bf16 v[80:83], a[208:211], a[52:55], v[80:83]
  v_mfma_f32_16x16x32_bf16 v[64:67], a[212:215], a[56:59], v[64:67]
  s_add_u32 s23, s22, 240640
  buffer_load_dwordx4 a[120:123], v3, s[64:67], s23 offen sc1
  v_mfma_f32_16x16x32_bf16 v[68:71], a[216:219], a[56:59], v[68:71]
  v_mfma_f32_16x16x32_bf16 v[72:75], a[220:223], a[56:59], v[72:75]
  s_add_u32 s23, s22, 12288
  buffer_load_dwordx4 a[124:127], v3, s[64:67], s23 offen sc1
  v_mfma_f32_16x16x32_bf16 v[76:79], a[224:227], a[56:59], v[76:79]
  v_mfma_f32_16x16x32_bf16 v[80:83], a[228:231], a[56:59], v[80:83]
  v_mfma_f32_16x16x32_bf16 v[64:67], a[232:235], a[60:63], v[64:67]
  s_add_u32 s23, s22, 69632
  buffer_load_dwordx4 a[128:131], v3, s[64:67], s23 offen sc1
  v_mfma_f32_16x16x32_bf16 v[68:71], a[236:239], a[60:63], v[68:71]
  v_mfma_f32_16x16x32_bf16 v[72:75], a[240:243], a[60:63], v[72:75]
  s_add_u32 s23, s22, 126976
  buffer_load_dwordx4 a[132:135], v3, s[64:67], s23 offen sc1
  v_mfma_f32_16x16x32_bf16 v[76:79], a[244:247], a[60:63], v[76:79]
  v_mfma_f32_16x16x32_bf16 v[80:83], a[248:251], a[60:63], v[80:83]
  s_add_u32 s62, s63, 32768
  s_buffer_load_dwordx8 s[40:47], s[8:11], s62 glc
  v_mfma_f32_16x16x32_bf16 v[64:67], a[252:255], a[64:67], v[64:67]
  s_add_u32 s23, s22, 184320
  buffer_load_dwordx4 a[136:139], v3, s[64:67], s23 offen sc1
  v_mfma_f32_16x16x32_bf16 v[68:71], v[252:255], a[64:67], v[68:71]
  v_mfma_f32_16x16x32_bf16 v[72:75], v[248:251], a[64:67], v[72:75]
  s_add_u32 s23, s22, 241664
  buffer_load_dwordx4 a[140:143], v3, s[64:67], s23 offen sc1
  v_mfma_f32_16x16x32_bf16 v[76:79], v[244:247], a[64:67], v[76:79]
  v_mfma_f32_16x16x32_bf16 v[80:83], v[240:243], a[64:67], v[80:83]
  v_mfma_f32_16x16x32_bf16 v[64:67], v[236:239], a[68:71], v[64:67]
  s_add_u32 s23, s22, 13312
  buffer_load_dwordx4 a[144:147], v3, s[64:67], s23 offen sc1
  v_mfma_f32_16x16x32_bf16 v[68:71], v[232:235], a[68:71], v[68:71]
  v_mfma_f32_16x16x32_bf16 v[72:75], v[228:231], a[68:71], v[72:75]
  s_add_u32 s23, s22, 70656
  buffer_load_dwordx4 a[148:151], v3, s[64:67], s23 offen sc1
  v_mfma_f32_16x16x32_bf16 v[76:79], v[224:227], a[68:71], v[76:79]
  v_mfma_f32_16x16x32_bf16 v[80:83], v[220:223], a[68:71], v[80:83]
  v_mfma_f32_16x16x32_bf16 v[84:87], a[172:175], a[72:75], 0
  s_add_u32 s23, s22, 128000
  buffer_load_dwordx4 a[152:155], v3, s[64:67], s23 offen sc1
  v_mfma_f32_16x16x32_bf16 v[88:91], a[176:179], a[72:75], 0
  v_mfma_f32_16x16x32_bf16 v[92:95], a[180:183], a[72:75], 0
  s_add_u32 s23, s22, 185344
  buffer_load_dwordx4 a[156:159], v3, s[64:67], s23 offen sc1
  v_mfma_f32_16x16x32_bf16 v[96:99], a[184:187], a[72:75], 0
  v_mfma_f32_16x16x32_bf16 v[100:103], a[188:191], a[72:75], 0
  v_mfma_f32_16x16x32_bf16 v[84:87], a[192:195], a[76:79], v[84:87]
  s_add_u32 s23, s22, 242688
  buffer_load_dwordx4 a[160:163], v3, s[64:67], s23 offen sc1
  v_mfma_f32_16x16x32_bf16 v[88:91], a[196:199], a[76:79], v[88:91]
  v_mfma_f32_16x16x32_bf16 v[92:95], a[200:203], a[76:79], v[92:95]
  buffer_load_dwordx2 v[104:105], v15, s[24:27], s48 offen offset:0 sc1
  v_mfma_f32_16x16x32_bf16 v[96:99], a[204:207], a[76:79], v[96:99]
  v_mfma_f32_16x16x32_bf16 v[100:103], a[208:211], a[76:79], v[100:103]
  s_waitcnt vmcnt(29)
  v_mfma_f32_16x16x32_bf16 v[84:87], a[212:215], a[80:83], v[84:87]
  buffer_load_dwordx2 v[106:107], v15, s[24:27], s48 offen offset:1024 sc1
  v_mfma_f32_16x16x32_bf16 v[88:91], a[216:219], a[80:83], v[88:91]
  v_mfma_f32_16x16x32_bf16 v[92:95], a[220:223], a[80:83], v[92:95]
  buffer_load_dwordx2 v[108:109], v15, s[24:27], s48 offen offset:2048 sc1
  v_mfma_f32_16x16x32_bf16 v[96:99], a[224:227], a[80:83], v[96:99]
  v_mfma_f32_16x16x32_bf16 v[100:103], a[228:231], a[80:83], v[100:103]
  s_waitcnt vmcnt(30)
  v_mfma_f32_16x16x32_bf16 v[84:87], a[232:235], a[84:87], v[84:87]
  buffer_load_dwordx2 v[110:111], v15, s[24:27], s48 offen offset:3072 sc1
  v_mfma_f32_16x16x32_bf16 v[88:91], a[236:239], a[84:87], v[88:91]
  v_mfma_f32_16x16x32_bf16 v[92:95], a[240:243], a[84:87], v[92:95]
  buffer_load_dwordx2 v[112:113], v15, s[24:27], s49 offen offset:0 sc1
  v_mfma_f32_16x16x32_bf16 v[96:99], a[244:247], a[84:87], v[96:99]
  v_mfma_f32_16x16x32_bf16 v[100:103], a[248:251], a[84:87], v[100:103]
  s_waitcnt vmcnt(31)
  v_mfma_f32_16x16x32_bf16 v[84:87], a[252:255], a[88:91], v[84:87]
  buffer_load_dword v114, v16, s[32:35], s50 offen sc1
  v_mfma_f32_16x16x32_bf16 v[88:91], v[252:255], a[88:91], v[88:91]
  v_mfma_f32_16x16x32_bf16 v[92:95], v[248:251], a[88:91], v[92:95]
  v_mfma_f32_16x16x32_bf16 v[96:99], v[244:247], a[88:91], v[96:99]
  v_mfma_f32_16x16x32_bf16 v[100:103], v[240:243], a[88:91], v[100:103]
  s_waitcnt lgkmcnt(0)
  s_and_b64 s[60:61], s[40:41], s[42:43]
  s_or_b64 s[40:41], s[40:41], s[42:43]
  s_and_b64 s[42:43], s[44:45], s[46:47]
  s_or_b64 s[44:45], s[44:45], s[46:47]
  s_and_b64 s[60:61], s[60:61], s[42:43]
  s_or_b64 s[40:41], s[40:41], s[44:45]
  s_and_b32 s60, s60, s61
  s_or_b32 s61, s40, s41
  s_mov_b32 s92, s93
  s_cmp_eq_u64 s[60:61], s[92:93]
  s_cbranch_scc1 M_f4_ok
  s_mov_b32 s92, 0
M_f4:
  buffer_load_dword v9, v7, s[8:11], s59 offen sc1
  s_add_u32 s92, s92, 1
  s_waitcnt vmcnt(0)
  s_cmp_gt_u32 s92, 400000
  s_cbranch_scc1 M_f4_ok
  v_cmp_ne_u32 vcc, s93, v9
  s_nop 4
  s_cbranch_vccnz M_f4
M_f4_ok:
  s_add_u32 s55, s96, 1
  s_and_b32 s55, s55, 3
  s_mul_i32 s55, s55, 57344
  s_add_u32 s55, s55, s57
  s_add_u32 s55, s55, 8192
  buffer_load_dwordx4 a[32:35], v3, s[36:39], s55 offen offset:0 sc1
  buffer_load_dwordx4 a[36:39], v3, s[36:39], s55 offen offset:1024 sc1
  buffer_load_dwordx4 a[40:43], v3, s[36:39], s55 offen offset:2048 sc1
  buffer_load_dwordx4 a[44:47], v3, s[36:39], s55 offen offset:3072 sc1
  s_add_u32 s55, s55, 4096
  buffer_load_dwordx4 a[48:51], v3, s[36:39], s55 offen offset:0 sc1
  buffer_load_dwordx4 a[52:55], v3, s[36:39], s55 offen offset:1024 sc1
  s_waitcnt vmcnt(37)
  v_mfma_f32_16x16x32_bf16 v[84:87], v[236:239], a[92:95], v[84:87]
  s_add_u32 s55, s96, 2
  s_and_b32 s55, s55, 3
  s_mul_i32 s55, s55, 57344
  s_add_u32 s55, s55, s57
  s_add_u32 s55, s55, 8192
  buffer_load_dwordx4 a[56:59], v3, s[36:39], s55 offen offset:0 sc1
  v_mfma_f32_16x16x32_bf16 v[88:91], v[232:235], a[92:95], v[88:91]
  v_mfma_f32_16x16x32_bf16 v[92:95], v[228:231], a[92:95], v[92:95]
  buffer_load_dwordx4 a[60:63], v3, s[36:39], s55 offen offset:1024 sc1
  v_mfma_f32_16x16x32_bf16 v[96:99], v[224:227], a[92:95], v[96:99]
  v_mfma_f32_16x16x32_bf16 v[100:103], v[220:223], a[92:95], v[100:103]
  s_waitcnt vmcnt(38)
  v_mfma_f32_16x16x32_bf16 v[24:27], v[216:219], a[0:3], v[24:27]
  buffer_load_dwordx4 a[64:67], v3, s[36:39], s55 offen offset:2048 sc1
  v_mfma_f32_16x16x32_bf16 v[28:31], v[212:215], a[0:3], v[28:31]
  v_mfma_f32_16x16x32_bf16 v[32:35], v[208:211], a[0:3], v[32:35]
  buffer_load_dwordx4 a[68:71], v3, s[36:39], s55 offen offset:3072 sc1
  v_mfma_f32_16x16x32_bf16 v[36:39], v[204:207], a[0:3], v[36:39]
  v_mfma_f32_16x16x32_bf16 v[40:43], v[200:203], a[0:3], v[40:43]
  s_waitcnt vmcnt(39)
  v_mfma_f32_16x16x32_bf16 v[24:27], v[196:199], a[4:7], v[24:27]
  s_add_u32 s55, s55, 4096
  buffer_load_dwordx4 a[72:75], v3, s[36:39], s55 offen offset:0 sc1
  v_mfma_f32_16x16x32_bf16 v[28:31], v[192:195], a[4:7], v[28:31]
  v_mfma_f32_16x16x32_bf16 v[32:35], v[188:191], a[4:7], v[32:35]
  v_mfma_f32_16x16x32_bf16 v[36:39], v[184:187], a[4:7], v[36:39]
  v_mfma_f32_16x16x32_bf16 v[40:43], v[180:183], a[4:7], v[40:43]
  s_waitcnt vmcnt(39)
  v_mfma_f32_16x16x32_bf16 v[44:47], v[216:219], a[8:11], v[44:47]
  buffer_load_dwordx4 a[76:79], v3, s[36:39], s55 offen offset:1024 sc1
  v_mfma_f32_16x16x32_bf16 v[48:51], v[212:215], a[8:11], v[48:51]
  v_mfma_f32_16x16x32_bf16 v[52:55], v[208:211], a[8:11], v[52:55]
  v_mfma_f32_16x16x32_bf16 v[56:59], v[204:207], a[8:11], v[56:59]
  v_mfma_f32_16x16x32_bf16 v[60:63], v[200:203], a[8:11], v[60:63]
  s_waitcnt vmcnt(39)
  v_mfma_f32_16x16x32_bf16 v[44:47], v[196:199], a[12:15], v[44:47]
  s_add_u32 s55, s96, 3
  s_and_b32 s55, s55, 3
  s_mul_i32 s55, s55, 57344
  s_add_u32 s55, s55, s57
  s_add_u32 s55, s55, 8192
  buffer_load_dwordx4 a[80:83], v3, s[36:39], s55 offen offset:0 sc1
  v_mfma_f32_16x16x32_bf16 v[48:51], v[192:195], a[12:15], v[48:51]
  v_mfma_f32_16x16x32_bf16 v[52:55], v[188:191], a[12:15], v[52:55]
  v_mfma_f32_16x16x32_bf16 v[56:59], v[184:187], a[12:15], v[56:59]
  v_mfma_f32_16x16x32_bf16 v[60:63], v[180:183], a[12:15], v[60:63]
  s_waitcnt vmcnt(39)
  v_mfma_f32_16x16x32_bf16 v[64:67], v[216:219], a[16:19], v[64:67]
  buffer_load_dwordx4 a[84:87], v3, s[36:39], s55 offen offset:1024 sc1
  v_mfma_f32_16x16x32_bf16 v[68:71], v[212:215], a[16:19], v[68:71]
  v_mfma_f32_16x16x32_bf16 v[72:75], v[208:211], a[16:19], v[72:75]
  v_mfma_f32_16x16x32_bf16 v[76:79], v[204:207], a[16:19], v[76:79]
  v_mfma_f32_16x16x32_bf16 v[80:83], v[200:203], a[16:19], v[80:83]
  s_waitcnt vmcnt(39)
  v_mfma_f32_16x16x32_bf16 v[64:67], v[196:199], a[20:23], v[64:67]
  buffer_load_dwordx4 a[88:91], v3, s[36:39], s55 offen offset:2048 sc1
  v_mfma_f32_16x16x32_bf16 v[68:71], v[192:195], a[20:23], v[68:71]
  v_mfma_f32_16x16x32_bf16 v[72:75], v[188:191], a[20:23], v[72:75]
  v_mfma_f32_16x16x32_bf16 v[76:79], v[184:187], a[20:23], v[76:79]
  v_mfma_f32_16x16x32_bf16 v[80:83], v[180:183], a[20:23], v[80:83]
  s_waitcnt vmcnt(39)
  v_mfma_f32_16x16x32_bf16 v[84:87], v[216:219], a[24:27], v[84:87]
  buffer_load_dwordx4 a[92:95], v3, s[36:39], s55 offen offset:3072 sc1
  v_mfma_f32_16x16x32_bf16 v[88:91], v[212:215], a[24:27], v[88:91]
  v_mfma_f32_16x16x32_bf16 v[92:95], v[208:211], a[24:27], v[92:95]
  v_mfma_f32_16x16x32_bf16 v[96:99], v[204:207], a[24:27], v[96:99]
  v_mfma_f32_16x16x32_bf16 v[100:103], v[200:203], a[24:27], v[100:103]
  s_waitcnt vmcnt(39)
  v_mfma_f32_16x16x32_bf16 v[84:87], v[196:199], a[28:31], v[84:87]
  s_add_u32 s55, s55, 4096
  buffer_load_dwordx4 a[0:3], v3, s[36:39], s55 offen offset:0 sc1
  v_mfma_f32_16x16x32_bf16 v[88:91], v[192:195], a[28:31], v[88:91]
  v_mfma_f32_16x16x32_bf16 v[92:95], v[188:191], a[28:31], v[92:95]
  v_mfma_f32_16x16x32_bf16 v[96:99], v[184:187], a[28:31], v[96:99]
  v_mfma_f32_16x16x32_bf16 v[100:103], v[180:183], a[28:31], v[100:103]
  s_waitcnt vmcnt(16)
  v_mfma_f32_16x16x32_bf16 v[24:27], v[176:179], a[32:35], v[24:27]
  buffer_load_dwordx4 a[4:7], v3, s[36:39], s55 offen offset:1024 sc1
  v_mfma_f32_16x16x32_bf16 v[28:31], v[172:175], a[32:35], v[28:31]
  v_mfma_f32_16x16x32_bf16 v[32:35], v[168:171], a[32:35], v[32:35]
  s_add_u32 s55, s96, 0
  s_and_b32 s55, s55, 3
  s_mul_i32 s55, s55, 57344
  s_add_u32 s55, s55, s57
  s_add_u32 s55, s55, 8192
  buffer_load_dwordx4 a[8:11], v3, s[36:39], s55 offen offset:0 sc1
  v_mfma_f32_16x16x32_bf16 v[36:39], v[164:167], a[32:35], v[36:39]
  v_mfma_f32_16x16x32_bf16 v[40:43], v[160:163], a[32:35], v[40:43]
  s_waitcnt vmcnt(17)
  v_mfma_f32_16x16x32_bf16 v[24:27], v[156:159], a[36:39], v[24:27]
  buffer_load_dwordx4 a[12:15], v3, s[36:39], s55 offen offset:1024 sc1
  v_mfma_f32_16x16x32_bf16 v[28:31], v[152:155], a[36:39], v[28:31]
  v_mfma_f32_16x16x32_bf16 v[32:35], v[148:151], a[36:39], v[32:35]
  buffer_load_dwordx4 a[16:19], v3, s[36:39], s55 offen offset:2048 sc1
  v_mfma_f32_16x16x32_bf16 v[36:39], v[144:147], a[36:39], v[36:39]
  v_mfma_f32_16x16x32_bf16 v[40:43], v[140:143], a[36:39], v[40:43]
  s_waitcnt vmcnt(18)
  v_mfma_f32_16x16x32_bf16 v[24:27], v[136:139], a[40:43], v[24:27]
  buffer_load_dwordx4 a[20:23], v3, s[36:39], s55 offen offset:3072 sc1
  v_mfma_f32_16x16x32_bf16 v[28:31], v[132:135], a[40:43], v[28:31]
  v_mfma_f32_16x16x32_bf16 v[32:35], v[128:131], a[40:43], v[32:35]
  s_add_u32 s55, s55, 4096
  buffer_load_dwordx4 a[24:27], v3, s[36:39], s55 offen offset:0 sc1
  v_mfma_f32_16x16x32_bf16 v[36:39], a[96:99], a[40:43], v[36:39]
  v_mfma_f32_16x16x32_bf16 v[40:43], a[100:103], a[40:43], v[40:43]
  s_waitcnt vmcnt(19)
  v_mfma_f32_16x16x32_bf16 v[24:27], a[104:107], a[44:47], v[24:27]
  buffer_load_dwordx4 a[28:31], v3, s[36:39], s55 offen offset:1024 sc1
  v_mfma_f32_16x16x32_bf16 v[28:31], a[108:111], a[44:47], v[28:31]
  v_mfma_f32_16x16x32_bf16 v[32:35], a[112:115], a[44:47], v[32:35]
  v_mfma_f32_16x16x32_bf16 v[36:39], a[116:119], a[44:47], v[36:39]
  v_mfma_f32_16x16x32_bf16 v[40:43], a[120:123], a[44:47], v[40:43]
  s_waitcnt vmcnt(19)
  v_mfma_f32_16x16x32_bf16 v[24:27], a[124:127], a[48:51], v[24:27]
  v_mfma_f32_16x16x32_bf16 v[28:31], a[128:131], a[48:51], v[28:31]
  v_mfma_f32_16x16x32_bf16 v[32:35], a[132:135], a[48:51], v[32:35]
  v_mfma_f32_16x16x32_bf16 v[36:39], a[136:139], a[48:51], v[36:39]
  v_mfma_f32_16x16x32_bf16 v[40:43], a[140:143], a[48:51], v[40:43]
  s_waitcnt vmcnt(18)
  v_mfma_f32_16x16x32_bf16 v[24:27], a[144:147], a[52:55], v[24:27]
  v_mfma_f32_16x16x32_bf16 v[28:31], a[148:151], a[52:55], v[28:31]
  v_mfma_f32_16x16x32_bf16 v[32:35], a[152:155], a[52:55], v[32:35]
  v_mfma_f32_16x16x32_bf16 v[36:39], a[156:159], a[52:55], v[36:39]
  v_mfma_f32_16x16x32_bf16 v[40:43], a[160:163], a[52:55], v[40:43]
  s_waitcnt vmcnt(17)
  v_mfma_f32_16x16x32_bf16 v[44:47], v[176:179], a[56:59], v[44:47]
  v_mfma_f32_16x16x32_bf16 v[48:51], v[172:175], a[56:59], v[48:51]
  v_mfma_f32_16x16x32_bf16 v[52:55], v[168:171], a[56:59], v[52:55]
  v_mfma_f32_16x16x32_bf16 v[56:59], v[164:167], a[56:59], v[56:59]
  v_mfma_f32_16x16x32_bf16 v[60:63], v[160:163], a[56:59], v[60:63]
  s_waitcnt vmcnt(16)
  v_mfma_f32_16x16x32_bf16 v[44:47], v[156:159], a[60:63], v[44:47]
  v_mfma_f32_16x16x32_bf16 v[48:51], v[152:155], a[60:63], v[48:51]
  ds_write_b128 v6, v[24:27] offset:0
  v_mfma_f32_16x16x32_bf16 v[52:55], v[148:151], a[60:63], v[52:55]
  v_mfma_f32_16x16x32_bf16 v[56:59], v[144:147], a[60:63], v[56:59]
  ds_write_b128 v6, v[28:31] offset:1024
  v_mfma_f32_16x16x32_bf16 v[60:63], v[140:143], a[60:63], v[60:63]
  ds_write_b128 v6, v[32:35] offset:2048
  s_waitcnt vmcnt(15)
  v_mfma_f32_16x16x32_bf16 v[44:47], v[136:139], a[64:67], v[44:47]
  v_mfma_f32_16x16x32_bf16 v[48:51], v[132:135], a[64:67], v[48:51]
  ds_write_b128 v6, v[36:39] offset:3072
  v_mfma_f32_16x16x32_bf16 v[52:55], v[128:131], a[64:67], v[52:55]
  v_mfma_f32_16x16x32_bf16 v[56:59], a[96:99], a[64:67], v[56:59]
  ds_write_b128 v6, v[40:43] offset:4096
  v_mfma_f32_16x16x32_bf16 v[60:63], a[100:103], a[64:67], v[60:63]
  s_waitcnt vmcnt(14)
  v_mfma_f32_16x16x32_bf16 v[44:47], a[104:107], a[68:71], v[44:47]
  v_lshlrev_b32 v116, 16, v104
  v_and_b32 v104, s54, v104
  v_mfma_f32_16x16x32_bf16 v[48:51], a[108:111], a[68:71], v[48:51]
  v_lshlrev_b32 v117, 16, v105
  v_and_b32 v105, s54, v105
  v_mfma_f32_16x16x32_bf16 v[52:55], a[112:115], a[68:71], v[52:55]
  v_lshlrev_b32 v118, 16, v106
  v_and_b32 v106, s54, v106
  v_mfma_f32_16x16x32_bf16 v[56:59], a[116:119], a[68:71], v[56:59]
  v_lshlrev_b32 v119, 16, v107
  v_and_b32 v107, s54, v107
  v_mfma_f32_16x16x32_bf16 v[60:63], a[120:123], a[68:71], v[60:63]
  v_lshlrev_b32 v120, 16, v108
  v_and_b32 v108, s54, v108
  s_waitcnt vmcnt(13)
  v_mfma_f32_16x16x32_bf16 v[44:47], a[124:127], a[72:75], v[44:47]
  v_lshlrev_b32 v121, 16, v109
  v_and_b32 v109, s54, v109
  v_mfma_f32_16x16x32_bf16 v[48:51], a[128:131], a[72:75], v[48:51]
  v_lshlrev_b32 v122, 16, v110
  v_and_b32 v110, s54, v110
  v_mfma_f32_16x16x32_bf16 v[52:55], a[132:135], a[72:75], v[52:55]
  v_lshlrev_b32 v123, 16, v111
  v_and_b32 v111, s54, v111
  v_mfma_f32_16x16x32_bf16 v[56:59], a[136:139], a[72:75], v[56:59]
  v_lshlrev_b32 v124, 16, v112
  v_and_b32 v112, s54, v112
  v_mfma_f32_16x16x32_bf16 v[60:63], a[140:143], a[72:75], v[60:63]
  v_lshlrev_b32 v125, 16, v113
  v_and_b32 v113, s54, v113
  s_waitcnt vmcnt(12)
  v_mfma_f32_16x16x32_bf16 v[44:47], a[144:147], a[76:79], v[44:47]
  v_mfma_f32_16x16x32_bf16 v[48:51], a[148:151], a[76:79], v[48:51]
  v_mfma_f32_16x16x32_bf16 v[52:55], a[152:155], a[76:79], v[52:55]
  v_mfma_f32_16x16x32_bf16 v[56:59], a[156:159], a[76:79], v[56:59]
  v_mfma_f32_16x16x32_bf16 v[60:63], a[160:163], a[76:79], v[60:63]
  s_waitcnt vmcnt(11)
  v_mfma_f32_16x16x32_bf16 v[64:67], v[176:179], a[80:83], v[64:67]
  v_mfma_f32_16x16x32_bf16 v[68:71], v[172:175], a[80:83], v[68:71]
  v_mfma_f32_16x16x32_bf16 v[72:75], v[168:171], a[80:83], v[72:75]
  v_mfma_f32_16x16x32_bf16 v[76:79], v[164:167], a[80:83], v[76:79]
  v_mfma_f32_16x16x32_bf16 v[80:83], v[160:163], a[80:83], v[80:83]
  s_waitcnt vmcnt(10)
  v_mfma_f32_16x16x32_bf16 v[64:67], v[156:159], a[84:87], v[64:67]
  v_mfma_f32_16x16x32_bf16 v[68:71], v[152:155], a[84:87], v[68:71]
  ds_write_b128 v6, v[44:47] offset:5120
  v_mfma_f32_16x16x32_bf16 v[72:75], v[148:151], a[84:87], v[72:75]
  v_mfma_f32_16x16x32_bf16 v[76:79], v[144:147], a[84:87], v[76:79]
  ds_write_b128 v6, v[48:51] offset:6144
  v_mfma_f32_16x16x32_bf16 v[80:83], v[140:143], a[84:87], v[80:83]
  ds_write_b128 v6, v[52:55] offset:7168
  s_waitcnt vmcnt(9)
  v_mfma_f32_16x16x32_bf16 v[64:67], v[136:139], a[88:91], v[64:67]
  v_mfma_f32_16x16x32_bf16 v[68:71], v[132:135], a[88:91], v[68:71]
  ds_write_b128 v6, v[56:59] offset:8192
  v_mfma_f32_16x16x32_bf16 v[72:75], v[128:131], a[88:91], v[72:75]
  v_mfma_f32_16x16x32_bf16 v[76:79], a[96:99], a[88:91], v[76:79]
  ds_write_b128 v6, v[60:63] offset:9216
  v_mfma_f32_16x16x32_bf16 v[80:83], a[100:103], a[88:91], v[80:83]
  s_waitcnt vmcnt(8)
  v_mfma_f32_16x16x32_bf16 v[64:67], a[104:107], a[92:95], v[64:67]
  v_mfma_f32_16x16x32_bf16 v[68:71], a[108:111], a[92:95], v[68:71]
  v_mfma_f32_16x16x32_bf16 v[72:75], a[112:115], a[92:95], v[72:75]
  v_mfma_f32_16x16x32_bf16 v[76:79], a[116:119], a[92:95], v[76:79]
  v_mfma_f32_16x16x32_bf16 v[80:83], a[120:123], a[92:95], v[80:83]
  s_waitcnt lgkmcnt(0)
  s_barrier
  s_waitcnt vmcnt(7)
  v_mfma_f32_16x16x32_bf16 v[64:67], a[124:127], a[0:3], v[64:67]
  ds_read_b128 v[24:27], v12 offset:0
  v_mfma_f32_16x16x32_bf16 v[68:71], a[128:131], a[0:3], v[68:71]
  ds_read_b128 v[28:31], v12 offset:1024
  v_mfma_f32_16x16x32_bf16 v[72:75], a[132:135], a[0:3], v[72:75]
  ds_read_b128 v[32:35], v12 offset:2048
  v_mfma_f32_16x16x32_bf16 v[76:79], a[136:139], a[0:3], v[76:79]
  ds_read_b128 v[36:39], v12 offset:3072
  v_mfma_f32_16x16x32_bf16 v[80:83], a[140:143], a[0:3], v[80:83]
  ds_read_b128 v[40:43], v12 offset:4096
  s_waitcnt vmcnt(6)
  v_mfma_f32_16x16x32_bf16 v[64:67], a[144:147], a[4:7], v[64:67]
  ds_read_b128 v[44:47], v11 offset:0
  v_mfma_f32_16x16x32_bf16 v[68:71], a[148:151], a[4:7], v[68:71]
  ds_read_b128 v[48:51], v11 offset:1024
  v_mfma_f32_16x16x32_bf16 v[72:75], a[152:155], a[4:7], v[72:75]
  ds_read_b128 v[52:55], v11 offset:2048
  v_mfma_f32_16x16x32_bf16 v[76:79], a[156:159], a[4:7], v[76:79]
  ds_read_b128 v[56:59], v11 offset:3072
  v_mfma_f32_16x16x32_bf16 v[80:83], a[160:163], a[4:7], v[80:83]
  ds_read_b128 v[60:63], v11 offset:4096
  s_waitcnt vmcnt(5)
  v_mfma_f32_16x16x32_bf16 v[84:87], v[176:179], a[8:11], v[84:87]
  v_mfma_f32_16x16x32_bf16 v[88:91], v[172:175], a[8:11], v[88:91]
  v_mfma_f32_16x16x32_bf16 v[92:95], v[168:171], a[8:11], v[92:95]
  v_mfma_f32_16x16x32_bf16 v[96:99], v[164:167], a[8:11], v[96:99]
  v_mfma_f32_16x16x32_bf16 v[100:103], v[160:163], a[8:11], v[100:103]
  s_waitcnt lgkmcnt(0)
  s_waitcnt vmcnt(4)
  v_mfma_f32_16x16x32_bf16 v[84:87], v[156:159], a[12:15], v[84:87]
  v_add_f32 v24, v24, v44
  v_add_f32 v25, v25, v45
  v_mfma_f32_16x16x32_bf16 v[88:91], v[152:155], a[12:15], v[88:91]
  ds_write_b128 v6, v[64:67] offset:10240
  v_mfma_f32_16x16x32_bf16 v[92:95], v[148:151], a[12:15], v[92:95]
  v_add_f32 v26, v26, v46
  v_add_f32 v27, v27, v47
  v_mfma_f32_16x16x32_bf16 v[96:99], v[144:147], a[12:15], v[96:99]
  ds_write_b128 v6, v[68:71] offset:11264
  v_mfma_f32_16x16x32_bf16 v[100:103], v[140:143], a[12:15], v[100:103]
  ds_write_b128 v6, v[72:75] offset:12288
  s_waitcnt vmcnt(3)
  v_mfma_f32_16x16x32_bf16 v[84:87], v[136:139], a[16:19], v[84:87]
  v_add_f32 v28, v28, v48
  v_add_f32 v29, v29, v49
  v_mfma_f32_16x16x32_bf16 v[88:91], v[132:135], a[16:19], v[88:91]
  ds_write_b128 v6, v[76:79] offset:13312
  v_mfma_f32_16x16x32_bf16 v[92:95], v[128:131], a[16:19], v[92:95]
  v_add_f32 v30, v30, v50
  v_add_f32 v31, v31, v51
  v_mfma_f32_16x16x32_bf16 v[96:99], a[96:99], a[16:19], v[96:99]
  ds_write_b128 v6, v[80:83] offset:14336
  v_mfma_f32_16x16x32_bf16 v[100:103], a[100:103], a[16:19], v[100:103]
  v_add_f32 v32, v32, v52
  v_add_f32 v33, v33, v53
  s_waitcnt vmcnt(2)
  v_mfma_f32_16x16x32_bf16 v[84:87], a[104:107], a[20:23], v[84:87]
  v_add_f32 v34, v34, v54
  v_add_f32 v35, v35, v55
  v_mfma_f32_16x16x32_bf16 v[88:91], a[108:111], a[20:23], v[88:91]
  v_add_f32 v36, v36, v56
  v_add_f32 v37, v37, v57
  v_mfma_f32_16x16x32_bf16 v[92:95], a[112:115], a[20:23], v[92:95]
  v_add_f32 v38, v38, v58
  v_add_f32 v39, v39, v59
  v_mfma_f32_16x16x32_bf16 v[96:99], a[116:119], a[20:23], v[96:99]
  v_add_f32 v40, v40, v60
  v_add_f32 v41, v41, v61
  v_mfma_f32_16x16x32_bf16 v[100:103], a[120:123], a[20:23], v[100:103]
  v_add_f32 v42, v42, v62
  v_add_f32 v43, v43, v63
  s_waitcnt lgkmcnt(0)
  s_barrier
  ds_read_b128 v[64:67], v10 offset:0
  ds_read_b128 v[68:71], v10 offset:1024
  ds_read_b128 v[72:75], v10 offset:2048
  ds_read_b128 v[76:79], v10 offset:3072
  ds_read_b128 v[80:83], v10 offset:4096
  s_waitcnt vmcnt(1)
  v_mfma_f32_16x16x32_bf16 v[84:87], a[124:127], a[24:27], v[84:87]
  v_fma_f32 v44, v24, v114, v116
  v_fma_f32 v45, v25, v114, v104
  v_mfma_f32_16x16x32_bf16 v[88:91], a[128:131], a[24:27], v[88:91]
  v_fma_f32 v46, v26, v114, v117
  v_fma_f32 v47, v27, v114, v105
  v_mfma_f32_16x16x32_bf16 v[92:95], a[132:135], a[24:27], v[92:95]
  v_fma_f32 v48, v28, v114, v118
  v_fma_f32 v49, v29, v114, v106
  v_mfma_f32_16x16x32_bf16 v[96:99], a[136:139], a[24:27], v[96:99]
  v_fma_f32 v50, v30, v114, v119
  v_fma_f32 v51, v31, v114, v107
  v_mfma_f32_16x16x32_bf16 v[100:103], a[140:143], a[24:27], v[100:103]
  v_fma_f32 v52, v32, v114, v120
  v_fma_f32 v53, v33, v114, v108
  s_waitcnt vmcnt(0)
  v_mfma_f32_16x16x32_bf16 v[84:87], a[144:147], a[28:31], v[84:87]
  v_fma_f32 v54, v34, v114, v121
  v_fma_f32 v55, v35, v114, v109
  v_mfma_f32_16x16x32_bf16 v[88:91], a[148:151], a[28:31], v[88:91]
  v_fma_f32 v56, v36, v114, v122
  v_fma_f32 v57, v37, v114, v110
  v_mfma_f32_16x16x32_bf16 v[92:95], a[152:155], a[28:31], v[92:95]
  v_fma_f32 v58, v38, v114, v123
  v_fma_f32 v59, v39, v114, v111
  v_mfma_f32_16x16x32_bf16 v[96:99], a[156:159], a[28:31], v[96:99]
  v_fma_f32 v60, v40, v114, v124
  v_fma_f32 v61, v41, v114, v112
  v_mfma_f32_16x16x32_bf16 v[100:103], a[160:163], a[28:31], v[100:103]
  v_fma_f32 v62, v42, v114, v125
  v_fma_f32 v63, v43, v114, v113
  s_waitcnt lgkmcnt(0)
  v_pk_fma_f32 v[44:45], v[64:65], v[114:115], v[44:45] op_sel_hi:[1,0,1]
  v_pk_fma_f32 v[46:47], v[66:67], v[114:115], v[46:47] op_sel_hi:[1,0,1]
  v_pk_fma_f32 v[48:49], v[68:69], v[114:115], v[48:49] op_sel_hi:[1,0,1]
  v_pk_fma_f32 v[50:51], v[70:71], v[114:115], v[50:51] op_sel_hi:[1,0,1]
  v_pk_fma_f32 v[52:53], v[72:73], v[114:115], v[52:53] op_sel_hi:[1,0,1]
  v_pk_fma_f32 v[54:55], v[74:75], v[114:115], v[54:55] op_sel_hi:[1,0,1]
  v_pk_fma_f32 v[56:57], v[76:77], v[114:115], v[56:57] op_sel_hi:[1,0,1]
  v_pk_fma_f32 v[58:59], v[78:79], v[114:115], v[58:59] op_sel_hi:[1,0,1]
  v_pk_fma_f32 v[60:61], v[80:81], v[114:115], v[60:61] op_sel_hi:[1,0,1]
  v_pk_fma_f32 v[62:63], v[82:83], v[114:115], v[62:63] op_sel_hi:[1,0,1]
  v_pk_fma_f32 v[44:45], v[84:85], v[114:115], v[44:45] op_sel_hi:[1,0,1]
  v_pk_fma_f32 v[46:47], v[86:87], v[114:115], v[46:47] op_sel_hi:[1,0,1]
  v_pk_fma_f32 v[48:49], v[88:89], v[114:115], v[48:49] op_sel_hi:[1,0,1]
  v_pk_fma_f32 v[50:51], v[90:91], v[114:115], v[50:51] op_sel_hi:[1,0,1]
  v_pk_fma_f32 v[52:53], v[92:93], v[114:115], v[52:53] op_sel_hi:[1,0,1]
  v_pk_fma_f32 v[54:55], v[94:95], v[114:115], v[54:55] op_sel_hi:[1,0,1]
  v_pk_fma_f32 v[56:57], v[96:97], v[114:115], v[56:57] op_sel_hi:[1,0,1]
  v_pk_fma_f32 v[58:59], v[98:99], v[114:115], v[58:59] op_sel_hi:[1,0,1]
  v_pk_fma_f32 v[60:61], v[100:101], v[114:115], v[60:61] op_sel_hi:[1,0,1]
  v_pk_fma_f32 v[62:63], v[102:103], v[114:115], v[62:63] op_sel_hi:[1,0,1]
  v_cvt_pk_bf16_f32 v24, v44, v45
  v_cvt_pk_bf16_f32 v25, v46, v47
  v_cvt_pk_bf16_f32 v26, v48, v49
  v_cvt_pk_bf16_f32 v27, v50, v51
  v_cvt_pk_bf16_f32 v28, v52, v53
  v_cvt_pk_bf16_f32 v29, v54, v55
  v_cvt_pk_bf16_f32 v30, v56, v57
  v_cvt_pk_bf16_f32 v31, v58, v59
  v_cvt_pk_bf16_f32 v32, v60, v61
  v_cvt_pk_bf16_f32 v33, v62, v63
  ds_write_b64 v17, v[24:25] offset:0
  ds_write_b64 v17, v[26:27] offset:32
  ds_write_b64 v17, v[28:29] offset:64
  ds_write_b64 v17, v[30:31] offset:96
  ds_write_b64 v17, v[32:33] offset:128
  s_waitcnt lgkmcnt(0)
  ds_read_b128 v[44:47], v18 offset:0
  ds_read_b128 v[48:51], v18 offset:1024
  ds_read_b128 v[52:55], v18 offset:2048
  s_waitcnt lgkmcnt(2)
  buffer_store_dwordx4 v[44:47], v19, s[12:15], s52 offen nt
  s_waitcnt lgkmcnt(1)
  buffer_store_dwordx4 v[48:51], v20, s[12:15], s52 offen nt
  s_waitcnt lgkmcnt(0)
  s_mov_b32 exec_hi, 0
  buffer_store_dwordx4 v[52:55], v21, s[12:15], s52 offen nt
M_exit:
  s_endpgm
CODE_END:
  s_endpgm
.section .rodata,"a"
.p2align 6
.amdhsa_kernel sequential_preLN__linear_kernel_hedgehog__glu_gated_geglu__prompt_kernel
  .amdhsa_next_free_vgpr 512
  .amdhsa_next_free_sgpr 102
  .amdhsa_accum_offset 256
  .amdhsa_group_segment_fixed_size 0
  .amdhsa_kernarg_size 88
  .amdhsa_user_sgpr_count 2
  .amdhsa_user_sgpr_kernarg_segment_ptr 1
  .amdhsa_system_sgpr_workgroup_id_x 1
  .amdhsa_float_denorm_mode_32 3
.end_amdhsa_kernel
```
